```python
import torch

def _softmax(x, axis=-1):
    return torch.softmax(x, dim=axis)
def _gelu(x):
    return torch.nn.functional.gelu(x, approximate="tanh")
def _silu(x):
    return torch.nn.functional.silu(x)
def _sigmoid(x):
    return torch.sigmoid(x)
def _layernorm(x, axis=-1, eps=1e-5):
    m = x.mean(dim=axis, keepdim=True)
    v = x.var(dim=axis, keepdim=True, unbiased=False)
    return (x - m) / torch.sqrt(v + eps)
def _scatter_add(tgt, idx, src, axis=0):
    return tgt.clone().index_add_(axis, idx, src)
def _segment_sum(src, seg, n):
    out = torch.zeros((n,) + src.shape[1:], dtype=src.dtype)
    return out.index_add_(0, seg, src)
def _pad(x, pw):
    flat = tuple(v for pair in reversed(pw) for v in pair)
    return torch.nn.functional.pad(x, flat)

kernel_name = 'gated_mix__sliding_block__glu_gated_glu__prompt'

def setup_inputs():

    _w = (lambda a: (lambda t: t.to(torch.bfloat16) if t.is_floating_point() else t)(torch.as_tensor(a)))
    def _A_setup():
        B, S, D = 1, 2048, 512
        return {
            "x": _w((lambda *s: torch.randn(*s, dtype=torch.bfloat16) * 0.05)(B, S, D)),
            "wqkv": _w((lambda *s: torch.randn(*s, dtype=torch.bfloat16) * 0.8)(D, 3 * D)),
            "wo": _w((lambda *s: torch.randn(*s, dtype=torch.bfloat16) * 0.05)(D, D)),
        }
    _A_in = _A_setup()

    def _B_setup():
        B, S, D, F = 1, 2048, 512, 1376
        return {
            "x": _w((lambda *s: torch.randn(*s, dtype=torch.bfloat16) * 0.05)(B, S, D)),
            "w_gate": _w((lambda *s: torch.randn(*s, dtype=torch.bfloat16) * 1.6)(D, F)),
            "w_up": _w((lambda *s: torch.randn(*s, dtype=torch.bfloat16) * 0.1)(D, F)),
            "w_down": _w((lambda *s: torch.randn(*s, dtype=torch.bfloat16) * 0.1)(F, D)),
        }
    _B_in = _B_setup()

    return {
        "A_x": _A_in["x"],
        "A_wqkv": _A_in["wqkv"],
        "A_wo": _A_in["wo"],
        "B_x": _B_in["x"],
        "B_w_gate": _B_in["w_gate"],
        "B_w_up": _B_in["w_up"],
        "B_w_down": _B_in["w_down"],
        "gate_w": _w((lambda *s: torch.randn(*s, dtype=torch.bfloat16) * 0.05)(512) * 16.0),
    }

def reference(A_x, A_wqkv, A_wo, B_x, B_w_gate, B_w_up, B_w_down, gate_w):
    def _A_ref(x, wqkv, wo):
        B, S, D = x.shape
        H = 32; Dh = D // H; W = 256
        qkv = (lambda x, *d: x.permute(*d))((x @ wqkv).reshape(B, S, 3, H, Dh), 2, 0, 3, 1, 4)
        q, k, v = qkv[0], qkv[1], qkv[2]
        scores = torch.einsum("bhqd,bhkd->bhqk", q, k) * (Dh ** -0.5)
        idx = torch.arange(S)
        mask = (idx[:, None] - idx[None, :] >= 0) & (idx[:, None] - idx[None, :] < W)
        scores = torch.where(mask[None, None], scores, -1e9)
        p = _softmax(scores, axis=-1)
        o = torch.einsum("bhqk,bhkd->bhqd", p, v)
        return (lambda x, *d: x.permute(*d))(o, 0, 2, 1, 3).reshape(B, S, D) @ wo

    def _B_ref(x, w_gate, w_up, w_down):
        g = torch.einsum("bsd,df->bsf", x, w_gate)
        u = torch.einsum("bsd,df->bsf", x, w_up)
        h = _sigmoid(g) * u
        return torch.einsum("bsf,fd->bsd", h, w_down)

    x = A_x
    g = _sigmoid((x * gate_w).sum(-1, keepdims=True))
    a = _A_ref(x, A_wqkv, A_wo)
    b = _B_ref(x, B_w_gate, B_w_up, B_w_down)
    return g * a + (1 - g) * b
```

```asm
; @launch grid=(256,1,1) block=(512,1,1) lds=163840
.amdgcn_target "amdgcn-amd-amdhsa--gfx950"
.text
.globl gated_mix__sliding_block__glu_gated_glu__prompt_kernel
.p2align 8
.type gated_mix__sliding_block__glu_gated_glu__prompt_kernel,@function
gated_mix__sliding_block__glu_gated_glu__prompt_kernel:
    s_load_dwordx4 s[64:67], s[0:1], 0
    s_cmp_ge_u32 s2, 256
    s_cbranch_scc1 L_exit
    v_lshrrev_b32 v1, 6, v0
    v_and_b32 v0, 63, v0
    v_readfirstlane_b32 s3, v1
    s_nop 0
    s_cmp_lg_u32 s3, 7
    s_cbranch_scc1 L_nocpf
    s_getpc_b64 s[86:87]
    s_bfe_u32 s4, s2, 0x40003
    s_mul_i32 s4, s4, 2304
    v_lshl_add_u32 v2, v0, 7, s4
    v_min_u32 v2, L_exit-L_nocpf, v2
    v_mov_b32 v3, s87
    v_add_co_u32 v2, vcc, s86, v2
    s_nop 1
    v_addc_co_u32 v3, vcc, 0, v3, vcc
    s_mov_b64 exec, 0x3ffff
    global_load_dword v63, v[2:3], off
    s_mov_b64 exec, -1
L_nocpf:
    v_lshrrev_b32 v125, 4, v0
    v_xor_b32 v126, v0, v125
    v_lshlrev_b32 v124, 7, v0
    v_and_b32 v126, 7, v126
    v_and_b32 v124, 0x1c00, v124
    v_lshl_add_u32 v8, v126, 4, v124
    v_xor_b32 v9, 0x2040, v8
    s_bfe_u32 s54, s2, 0x30003
    s_lshr_b32 s53, s2, 6
    s_and_b32 s40, s2, 1
    s_lshl3_add_u32 s40, s40, s54
    s_lshl1_add_u32 s43, s53, s54
    s_and_b32 s43, s43, 7
    s_and_b32 s42, s3, 3
    s_lshr_b32 s62, s3, 2
    s_lshl2_add_u32 s98, s40, s42
    s_lshl1_add_u32 s45, s98, s62
    s_lshl_b32 s45, s45, 14
    s_lshl1_add_u32 s50, s42, s62
    s_lshl_b32 s50, s50, 11
    s_lshl_b32 s52, s43, 7
    s_add_u32 s52, s52, s45
    s_mov_b32 s6, 0x200000
    s_mov_b32 s7, 0x20000
    s_add_u32 m0, s50, 49152
    s_waitcnt lgkmcnt(0)
    s_mov_b64 s[4:5], s[64:65]
    buffer_load_dwordx4 v8, s[4:7], s52 offen lds
    s_add_u32 m0, s50, 50176
    s_load_dwordx8 s[68:75], s[0:1], 16
    buffer_load_dwordx4 v9, s[4:7], s52 offen lds
    s_load_dwordx8 s[76:83], s[0:1], 48
    s_load_dwordx2 s[84:85], s[0:1], 80
    v_lshlrev_b32 v15, 4, v0
    v_lshrrev_b32 v124, 2, v0
    v_and_b32 v125, 32, v0
    v_xor_b32 v125, v125, v15
    v_and_b32 v125, 48, v125
    v_mul_u32_u24 v10, 3072, v124
    v_add_u32 v10, v10, v125
    s_bfe_u32 s41, s2, 0x20001
    s_lshl2_add_u32 s41, s41, s53
    s_mul_i32 s49, s42, 3072
    s_lshl_b32 s46, s49, 4
    s_lshl_b32 s3, s41, 6
    s_add_u32 s46, s46, s3
    s_lshl_b32 s3, s62, 11
    s_add_u32 s46, s46, s3
    s_add_u32 s49, s49, s3
    s_mul_i32 s54, s43, 196608
    s_add_u32 s54, s54, s46
    s_mov_b64 s[8:9], s[66:67]
    s_mov_b32 s10, 0x180000
    s_mov_b32 s11, 0x20000
    s_add_u32 m0, s49, 65536
    s_lshl_b32 s55, s62, 30
    buffer_load_dwordx4 v10, s[8:11], s54 offen lds
    v_add_u32 v11, s55, v10
    s_cmp_eq_u32 s62, 0
    s_cselect_b32 m0, m0, 16384
    v_mul_u32_u24 v13, 2752, v124
    buffer_load_dwordx4 v11, s[8:11], s54 offen offset:1024 lds
    s_cselect_b32 m0, 17408, m0
    v_add_u32 v13, v13, v125
    s_lshl_b32 s3, s43, 7
    v_add_u32 v124, s3, v15
    v_and_b32 v124, 1023, v124
    s_xor_b32 s3, s55, 0x40000000
    v_add_u32 v124, s3, v124
    s_lshl_b32 s48, s42, 12
    s_waitcnt lgkmcnt(0)
    s_mov_b64 s[36:37], s[78:79]
    s_mov_b32 s38, 0x400
    s_mov_b32 s39, 0x20000
    buffer_load_dwordx4 v124, s[36:39], 0 offen lds
    s_cmp_lg_u32 s62, 0
    s_cbranch_scc1 L_hd1
    s_mov_b64 s[12:13], s[72:73]
    s_mov_b32 s14, 0x158000
    s_mov_b32 s15, 0x20000
    s_mov_b64 s[24:25], s[84:85]
    s_mov_b32 s26, 0x1000000
    s_mov_b32 s27, 0x20000
    s_mov_b64 s[32:33], s[82:83]
    s_mov_b32 s34, 0x100
    s_mov_b32 s35, 0x20000
    s_or_b32 s3, s2, s42
    v_or_b32 v124, s3, v0
    v_cmp_ne_u32 vcc, 0, v124
    v_mov_b32 v125, 0x40000000
    s_nop 0
    v_cndmask_b32_e64 v126, 0, v125, vcc
    buffer_load_dword v127, v126, s[24:27], 0 offen sc1
    s_mov_b64 s[16:17], s[76:77]
    s_mov_b32 s18, 0x158000
    s_mov_b32 s19, 0x20000
    s_mov_b64 s[20:21], s[68:69]
    s_mov_b32 s22, 0x80000
    s_mov_b32 s23, 0x20000
    s_mov_b64 s[28:29], s[80:81]
    s_mov_b32 s30, 0x200000
    s_mov_b32 s31, 0x20000
    v_and_b32 v124, 15, v0
    v_lshrrev_b32 v125, 4, v0
    v_bfe_u32 v5, v0, 1, 3
    v_xor_b32 v5, v5, v125
    v_lshlrev_b32 v5, 4, v5
    v_lshl_add_u32 v5, v124, 7, v5
    v_add_u32 v4, s48, v5
    v_xor_b32 v5, 64, v4
    v_bfe_u32 v124, v0, 4, 1
    v_bfe_u32 v125, v0, 2, 2
    v_lshlrev_b32 v125, 6, v125
    v_mul_u32_u24 v2, 544, v124
    v_add_u32 v125, v125, v2
    v_lshrrev_b32 v124, 5, v0
    v_mul_u32_u24 v124, 3072, v124
    v_add_u32 v125, v125, v124
    v_and_b32 v7, 3, v0
    v_lshl_add_u32 v7, v7, 3, v125
    v_xor_b32 v12, 32, v7
    v_and_b32 v6, 1, v0
    v_lshl_add_u32 v125, v6, 4, v125
    v_bfe_u32 v6, v0, 1, 1
    v_lshl_add_u32 v6, v6, 3, v125
    v_add_u32 v2, v124, v6
    s_lshr_b32 s52, s41, 2
    s_mul_i32 s52, s52, 11
    s_and_b32 s53, s41, 3
    s_mul_i32 s54, s53, 3
    s_add_u32 s96, s52, s54
    s_cmp_eq_u32 s41, 15
    s_subb_u32 s96, s96, 0
    s_cmp_eq_u32 s53, 3
    s_cselect_b32 s97, 0x40000000, 0
    s_cmp_eq_u32 s41, 14
    s_cselect_b32 s97, 0x40000000, s97
    v_add_u32 v14, s97, v13
    s_mul_i32 s47, s42, 44032
    s_lshl_b32 s3, s96, 6
    s_add_u32 s47, s47, s3
    s_mul_i32 s50, s42, 6144
    s_lshl_b32 s51, s42, 11
    s_mul_i32 s61, s42, 2080
    s_mul_i32 s52, s98, 120832
    s_lshl_b32 s3, s96, 11
    s_add_u32 s57, s52, s3
    s_add_u32 s57, s57, 8388608
    s_lshl_b32 s53, s41, 6
    s_add_u32 s3, s53, s98
    s_lshl_b32 s56, s3, 12
    s_add_u32 s56, s56, 1048576
    s_lshl_b32 s0, s3, 7
    s_add_u32 s0, s0, 5242880
    s_lshl4_add_u32 s1, s98, s41
    s_lshl_b32 s1, s1, 7
    s_add_u32 s1, s1, 5505024
    s_lshl_b32 s3, s41, 11
    s_add_u32 s41, s52, s3
    s_add_u32 s41, s41, 8476672
    s_sub_u32 s3, s98, 8
    s_cselect_b32 s40, 0x40000000, 0
    s_cselect_b32 s98, 0x200, -1
    s_max_i32 s3, s3, 0
    s_add_u32 s3, s3, s53
    s_lshl_b32 s99, s3, 12
    s_add_u32 s99, s99, 1048576
    s_lshl_b32 s96, s3, 7
    s_add_u32 s96, s96, 5242880
    s_and_b32 s52, s2, 7
    s_bfe_u32 s54, s2, 0x30003
    s_lshr_b32 s59, s2, 6
    s_and_b32 s3, s2, 1
    s_lshl2_add_u32 s59, s3, s59
    s_lshr_b32 s52, s52, 1
    s_lshl3_add_u32 s58, s52, s54
    s_lshl_b32 s58, s58, 1
    s_cmp_ge_u32 s52, 3
    s_cselect_b32 s62, 0, s52
    s_mul_i32 s3, s42, 22
    s_lshl_b32 s36, s3, 14
    s_lshl_b32 s52, s59, 7
    s_add_u32 s36, s36, s52
    s_lshl_b32 s3, s3, 10
    s_mul_i32 s38, s58, 120832
    s_add_u32 s38, s38, 8388608
    s_add_u32 s37, s38, s3
    s_lshl2_add_u32 s3, s58, s42
    s_lshl_b32 s59, s3, 13
    s_add_u32 s59, s59, s52
    s_lshl_b32 s58, s3, 9
    s_add_u32 s58, s58, 5505024
    v_and_b32 v124, 31, v0
    v_lshrrev_b32 v125, 5, v0
    v_lshlrev_b32 v125, 2, v125
    v_sub_u32 v124, v124, v125
    v_cmp_le_i32_e64 s[64:65], 0, v124
    v_cmp_le_i32_e64 s[66:67], 1, v124
    v_cmp_le_i32_e64 s[68:69], 2, v124
    v_cmp_le_i32_e64 s[70:71], 3, v124
    v_cmp_le_i32_e64 s[72:73], 8, v124
    v_cmp_le_i32_e64 s[74:75], 9, v124
    v_cmp_le_i32_e64 s[76:77], 10, v124
    v_cmp_le_i32_e64 s[78:79], 11, v124
    v_cmp_le_i32_e64 s[80:81], 16, v124
    v_cmp_le_i32_e64 s[82:83], 17, v124
    v_cmp_le_i32_e64 s[84:85], 18, v124
    v_cmp_le_i32_e64 s[86:87], 19, v124
    v_cmp_le_i32_e64 s[88:89], 24, v124
    v_cmp_le_i32_e64 s[90:91], 25, v124
    v_cmp_le_i32_e64 s[92:93], 26, v124
    v_cmp_le_i32_e64 s[94:95], 27, v124
    v_mov_b32 v44, 0xffff
    v_mov_b32 v45, 0xffff0000
    v_cndmask_b32_e64 v46, 0, v44, s[64:65]
    v_cndmask_b32_e64 v24, 0, v45, s[66:67]
    v_or_b32 v24, v46, v24
    v_cndmask_b32_e64 v46, 0, v44, s[68:69]
    v_cndmask_b32_e64 v25, 0, v45, s[70:71]
    v_or_b32 v25, v46, v25
    v_cndmask_b32_e64 v46, 0, v44, s[72:73]
    v_cndmask_b32_e64 v26, 0, v45, s[74:75]
    v_or_b32 v26, v46, v26
    v_cndmask_b32_e64 v46, 0, v44, s[76:77]
    v_cndmask_b32_e64 v27, 0, v45, s[78:79]
    v_or_b32 v27, v46, v27
    v_cndmask_b32_e64 v46, 0, v44, s[80:81]
    v_cndmask_b32_e64 v28, 0, v45, s[82:83]
    v_or_b32 v28, v46, v28
    v_cndmask_b32_e64 v46, 0, v44, s[84:85]
    v_cndmask_b32_e64 v29, 0, v45, s[86:87]
    v_or_b32 v29, v46, v29
    v_cndmask_b32_e64 v46, 0, v44, s[88:89]
    v_cndmask_b32_e64 v30, 0, v45, s[90:91]
    v_or_b32 v30, v46, v30
    v_cndmask_b32_e64 v46, 0, v44, s[92:93]
    v_cndmask_b32_e64 v31, 0, v45, s[94:95]
    v_or_b32 v31, v46, v31
    v_lshrrev_b32 v44, 5, v0
    v_bfe_u32 v45, v0, 2, 2
    v_lshl_add_u32 v44, v44, 2, v45
    v_lshlrev_b32 v44, 7, v44
    v_bfe_u32 v45, v0, 3, 1
    v_lshl_add_u32 v44, v45, 6, v44
    v_bfe_u32 v45, v0, 4, 1
    v_lshl_add_u32 v44, v45, 5, v44
    v_and_b32 v45, 3, v0
    v_lshl_add_u32 v32, v45, 3, v44
    v_and_b32 v44, 16, v0
    v_cmp_eq_u32 vcc, 0, v44
    v_add_u32 v44, 30816, v15
    v_mov_b32 v45, 31840
    v_cndmask_b32_e64 v33, v45, v44, vcc
    v_lshrrev_b32 v44, 4, v0
    v_bfe_u32 v45, v0, 3, 1
    v_lshl_add_u32 v35, v45, 2, v44
    v_lshlrev_b32 v44, 8, v44
    v_lshl_add_u32 v44, v45, 7, v44
    v_and_b32 v45, 7, v0
    v_lshlrev_b32 v45, 4, v45
    v_lshl_add_u32 v35, v35, 10, v45
    v_and_b32 v45, 3, v0
    v_lshl_add_u32 v44, v45, 5, v44
    v_bfe_u32 v45, v0, 2, 1
    v_mul_u32_u24 v45, 4112, v45
    v_add_u32 v34, v44, v45
    v_bfe_u32 v44, v0, 4, 1
    v_lshlrev_b32 v44, 2, v44
    v_and_b32 v45, 7, v0
    v_xor_b32 v44, v44, v45
    v_lshlrev_b32 v44, 4, v44
    v_lshrrev_b32 v45, 3, v0
    v_lshl_add_u32 v36, v45, 10, v44
    s_lshr_b32 s3, s2, 3
    s_lshl_b32 s3, s3, 14
    s_add_u32 s3, s3, 0
    s_and_b32 s52, s2, 1
    s_lshl_b32 s52, s52, 9
    s_add_u32 s3, s3, s52
    v_and_b32 v44, 3, v0
    v_lshl_add_u32 v44, v44, 7, s3
    v_bfe_u32 v45, v0, 2, 1
    v_lshl_add_u32 v44, v45, 10, v44
    v_cmp_gt_u32 vcc, 8, v0
    v_mov_b32 v45, 0x40000000
    s_nop 0
    v_cndmask_b32_e64 v37, v45, v44, vcc
    v_bfe_u32 v44, v0, 3, 1
    v_and_b32 v45, 1, v0
    v_lshl_add_u32 v44, v44, 5, v45
    v_bfe_u32 v45, v0, 1, 2
    v_lshl_add_u32 v39, v45, 1, v44
    v_lshlrev_b32 v39, 6, v39
    v_add_u32 v39, 262144, v39
    v_min_u32 v45, 2, v45
    v_lshl_add_u32 v38, v45, 1, v44
    v_lshlrev_b32 v38, 6, v38
    ds_write_b128 v15, v[24:27] offset:8192
    ds_write_b128 v15, v[28:31] offset:9216
    ds_write_b128 v15, v[32:35] offset:10240
    ds_write_b128 v15, v[36:39] offset:11264
    s_add_u32 s52, s43, 1
    s_and_b32 s52, s52, 7
    s_lshl_b32 s53, s52, 7
    s_add_u32 m0, s48, 77824
    s_add_u32 s53, s53, s45
    buffer_load_dwordx4 v8, s[4:7], s53 offen lds
    s_add_u32 m0, s48, 78848
    s_mul_i32 s54, s52, 196608
    buffer_load_dwordx4 v9, s[4:7], s53 offen lds
    s_add_u32 m0, s49, 94208
    s_add_u32 s54, s54, s46
    buffer_load_dwordx4 v10, s[8:11], s54 offen offset:0 lds
    buffer_load_dwordx4 v10, s[8:11], s54 offen offset:1024 lds
    s_waitcnt vmcnt(5) lgkmcnt(0)
    s_barrier
    ds_read_b128 a[0:3], v4 offset:49152
    ds_read_b128 a[4:7], v4 offset:51200
    v_add_u32 v6, 0x10000, v6
    ds_read_b64_tr_b16 v[96:97], v6 offset:0
    ds_read_b64_tr_b16 v[98:99], v6 offset:256
    ds_read_b64_tr_b16 v[100:101], v6 offset:1024
    ds_read_b64_tr_b16 v[102:103], v6 offset:1280
    v_add_u32 v7, 0x10800, v7
    ds_read_b64_tr_b16 v[104:105], v7 offset:0
    ds_read_b64_tr_b16 v[106:107], v7 offset:256
    v_add_u32 v12, 0x10800, v12
    ds_read_b64_tr_b16 v[108:109], v12 offset:0
    ds_read_b64_tr_b16 v[110:111], v12 offset:256
    ds_read_b128 a[8:11], v5 offset:49152
    ds_read_b128 a[12:15], v5 offset:51200
    ds_read_b64_tr_b16 v[112:113], v6 offset:6144
    ds_read_b64_tr_b16 v[114:115], v6 offset:6400
    s_waitcnt lgkmcnt(10)
    v_mfma_f32_16x16x32_bf16 v[64:67], v[96:99], a[0:3], 0
    ds_read_b64_tr_b16 v[116:117], v6 offset:7168
    v_mfma_f32_16x16x32_bf16 v[68:71], v[96:99], a[4:7], 0
    ds_read_b64_tr_b16 v[118:119], v6 offset:7424
    s_add_u32 s52, s43, 2
    s_and_b32 s52, s52, 7
    s_lshl_b32 s53, s52, 7
    s_add_u32 m0, s48, 106496
    s_add_u32 s53, s53, s45
    buffer_load_dwordx4 v8, s[4:7], s53 offen lds
    s_waitcnt lgkmcnt(10)
    v_mfma_f32_16x16x32_bf16 v[72:75], v[100:103], a[0:3], 0
    ds_read_b64_tr_b16 v[96:97], v7 offset:6144
    v_mfma_f32_16x16x32_bf16 v[76:79], v[100:103], a[4:7], 0
    ds_read_b64_tr_b16 v[98:99], v7 offset:6400
    s_add_u32 m0, s48, 107520
    s_mul_i32 s54, s52, 196608
    buffer_load_dwordx4 v9, s[4:7], s53 offen lds
    s_waitcnt lgkmcnt(10)
    v_mfma_f32_16x16x32_bf16 v[80:83], a[0:3], v[104:107], 0
    ds_read_b64_tr_b16 v[100:101], v12 offset:6144
    v_mfma_f32_16x16x32_bf16 v[88:91], a[4:7], v[104:107], 0
    ds_read_b64_tr_b16 v[102:103], v12 offset:6400
    s_add_u32 m0, s49, 122880
    s_add_u32 s54, s54, s46
    buffer_load_dwordx4 v10, s[8:11], s54 offen offset:0 lds
    s_waitcnt lgkmcnt(10)
    v_mfma_f32_16x16x32_bf16 v[84:87], a[0:3], v[108:111], 0
    v_mfma_f32_16x16x32_bf16 v[92:95], a[4:7], v[108:111], 0
    buffer_load_dwordx4 v10, s[8:11], s54 offen offset:1024 lds
    s_add_u32 s52, s43, 3
    s_and_b32 s52, s52, 7
    s_lshl_b32 s53, s52, 7
    s_add_u32 m0, s48, 135168
    s_add_u32 s53, s53, s45
    buffer_load_dwordx4 v8, s[4:7], s53 offen lds
    s_add_u32 m0, s48, 136192
    s_mul_i32 s54, s52, 196608
    buffer_load_dwordx4 v9, s[4:7], s53 offen lds
    s_add_u32 m0, s49, 151552
    s_add_u32 s54, s54, s46
    buffer_load_dwordx4 v10, s[8:11], s54 offen offset:0 lds
    buffer_load_dwordx4 v10, s[8:11], s54 offen offset:1024 lds
    s_waitcnt vmcnt(8) lgkmcnt(0)
    s_barrier
    v_mfma_f32_16x16x32_bf16 v[64:67], v[112:115], a[8:11], v[64:67]
    v_add_u32 v4, 0x13000, v4
    ds_read_b128 a[16:19], v4 offset:0
    v_mfma_f32_16x16x32_bf16 v[68:71], v[112:115], a[12:15], v[68:71]
    ds_read_b128 a[20:23], v4 offset:2048
    ds_read_b64_tr_b16 v[104:105], v6 offset:28672
    ds_read_b64_tr_b16 v[106:107], v6 offset:28928
    ds_read_b64_tr_b16 v[108:109], v6 offset:29696
    ds_read_b64_tr_b16 v[110:111], v6 offset:29952
    s_add_u32 s52, s43, 4
    s_and_b32 s52, s52, 7
    s_lshl_b32 s53, s52, 7
    s_add_u32 m0, s48, 49152
    s_add_u32 s53, s53, s45
    buffer_load_dwordx4 v8, s[4:7], s53 offen lds
    v_mfma_f32_16x16x32_bf16 v[72:75], v[116:119], a[8:11], v[72:75]
    ds_read_b64_tr_b16 v[112:113], v7 offset:28672
    v_mfma_f32_16x16x32_bf16 v[76:79], v[116:119], a[12:15], v[76:79]
    ds_read_b64_tr_b16 v[114:115], v7 offset:28928
    v_mfma_f32_16x16x32_bf16 v[80:83], a[8:11], v[96:99], v[80:83]
    ds_read_b64_tr_b16 v[116:117], v12 offset:28672
    v_mfma_f32_16x16x32_bf16 v[88:91], a[12:15], v[96:99], v[88:91]
    ds_read_b64_tr_b16 v[118:119], v12 offset:28928
    s_add_u32 m0, s48, 50176
    s_mul_i32 s54, s52, 196608
    buffer_load_dwordx4 v9, s[4:7], s53 offen lds
    v_mfma_f32_16x16x32_bf16 v[84:87], a[8:11], v[100:103], v[84:87]
    v_add_u32 v5, 0x13000, v5
    ds_read_b128 a[24:27], v5 offset:0
    v_mfma_f32_16x16x32_bf16 v[92:95], a[12:15], v[100:103], v[92:95]
    ds_read_b128 a[28:31], v5 offset:2048
    ds_read_b64_tr_b16 v[96:97], v6 offset:34816
    ds_read_b64_tr_b16 v[98:99], v6 offset:35072
    s_waitcnt lgkmcnt(10)
    v_mfma_f32_16x16x32_bf16 v[64:67], v[104:107], a[16:19], v[64:67]
    ds_read_b64_tr_b16 v[100:101], v6 offset:35840
    v_mfma_f32_16x16x32_bf16 v[68:71], v[104:107], a[20:23], v[68:71]
    ds_read_b64_tr_b16 v[102:103], v6 offset:36096
    s_add_u32 m0, s49, 65536
    s_add_u32 s54, s54, s46
    buffer_load_dwordx4 v10, s[8:11], s54 offen offset:0 lds
    s_waitcnt lgkmcnt(10)
    v_mfma_f32_16x16x32_bf16 v[72:75], v[108:111], a[16:19], v[72:75]
    ds_read_b64_tr_b16 v[104:105], v7 offset:34816
    v_mfma_f32_16x16x32_bf16 v[76:79], v[108:111], a[20:23], v[76:79]
    ds_read_b64_tr_b16 v[106:107], v7 offset:35072
    s_waitcnt lgkmcnt(10)
    v_mfma_f32_16x16x32_bf16 v[80:83], a[16:19], v[112:115], v[80:83]
    ds_read_b64_tr_b16 v[108:109], v12 offset:34816
    v_mfma_f32_16x16x32_bf16 v[88:91], a[20:23], v[112:115], v[88:91]
    ds_read_b64_tr_b16 v[110:111], v12 offset:35072
    buffer_load_dwordx4 v10, s[8:11], s54 offen offset:1024 lds
    s_waitcnt lgkmcnt(10)
    v_mfma_f32_16x16x32_bf16 v[84:87], a[16:19], v[116:119], v[84:87]
    v_mfma_f32_16x16x32_bf16 v[92:95], a[20:23], v[116:119], v[92:95]
    s_waitcnt vmcnt(8) lgkmcnt(0)
    s_barrier
    v_mfma_f32_16x16x32_bf16 v[64:67], v[96:99], a[24:27], v[64:67]
    ds_read_b128 a[32:35], v4 offset:28672
    v_mfma_f32_16x16x32_bf16 v[68:71], v[96:99], a[28:31], v[68:71]
    ds_read_b128 a[36:39], v4 offset:30720
    ds_read_b64_tr_b16 v[112:113], v6 offset:57344
    ds_read_b64_tr_b16 v[114:115], v6 offset:57600
    ds_read_b64_tr_b16 v[116:117], v6 offset:58368
    ds_read_b64_tr_b16 v[118:119], v6 offset:58624
    s_add_u32 s52, s43, 5
    s_and_b32 s52, s52, 7
    s_lshl_b32 s53, s52, 7
    s_add_u32 m0, s48, 77824
    s_add_u32 s53, s53, s45
    buffer_load_dwordx4 v8, s[4:7], s53 offen lds
    v_or_b32 v127, 1, v127
    v_add_u32 v127, 0x9e3779b8, v127
    buffer_store_dword v127, v126, s[24:27], 0 offen sc1
    buffer_store_dword v127, v126, s[32:35], 0 offen sc1
    v_mfma_f32_16x16x32_bf16 v[72:75], v[100:103], a[24:27], v[72:75]
    ds_read_b64_tr_b16 v[96:97], v7 offset:57344
    v_mfma_f32_16x16x32_bf16 v[76:79], v[100:103], a[28:31], v[76:79]
    ds_read_b64_tr_b16 v[98:99], v7 offset:57600
    v_mfma_f32_16x16x32_bf16 v[80:83], a[24:27], v[104:107], v[80:83]
    ds_read_b64_tr_b16 v[100:101], v12 offset:57344
    v_mfma_f32_16x16x32_bf16 v[88:91], a[28:31], v[104:107], v[88:91]
    ds_read_b64_tr_b16 v[102:103], v12 offset:57600
    s_add_u32 m0, s48, 78848
    s_mul_i32 s54, s52, 196608
    buffer_load_dwordx4 v9, s[4:7], s53 offen lds
    v_mfma_f32_16x16x32_bf16 v[84:87], a[24:27], v[108:111], v[84:87]
    ds_read_b128 a[40:43], v5 offset:28672
    v_mfma_f32_16x16x32_bf16 v[92:95], a[28:31], v[108:111], v[92:95]
    ds_read_b128 a[44:47], v5 offset:30720
    ds_read_b64_tr_b16 v[104:105], v6 offset:63488
    ds_read_b64_tr_b16 v[106:107], v6 offset:63744
    s_waitcnt lgkmcnt(10)
    v_mfma_f32_16x16x32_bf16 v[64:67], v[112:115], a[32:35], v[64:67]
    ds_read_b64_tr_b16 v[108:109], v6 offset:64512
    v_mfma_f32_16x16x32_bf16 v[68:71], v[112:115], a[36:39], v[68:71]
    ds_read_b64_tr_b16 v[110:111], v6 offset:64768
    s_add_u32 m0, s49, 94208
    s_add_u32 s54, s54, s46
    buffer_load_dwordx4 v10, s[8:11], s54 offen offset:0 lds
    s_waitcnt lgkmcnt(10)
    v_mfma_f32_16x16x32_bf16 v[72:75], v[116:119], a[32:35], v[72:75]
    ds_read_b64_tr_b16 v[112:113], v7 offset:63488
    v_mfma_f32_16x16x32_bf16 v[76:79], v[116:119], a[36:39], v[76:79]
    ds_read_b64_tr_b16 v[114:115], v7 offset:63744
    s_waitcnt lgkmcnt(10)
    v_mfma_f32_16x16x32_bf16 v[80:83], a[32:35], v[96:99], v[80:83]
    ds_read_b64_tr_b16 v[116:117], v12 offset:63488
    v_mfma_f32_16x16x32_bf16 v[88:91], a[36:39], v[96:99], v[88:91]
    ds_read_b64_tr_b16 v[118:119], v12 offset:63744
    buffer_load_dwordx4 v10, s[8:11], s54 offen offset:1024 lds
    s_waitcnt lgkmcnt(10)
    v_mfma_f32_16x16x32_bf16 v[84:87], a[32:35], v[100:103], v[84:87]
    v_mfma_f32_16x16x32_bf16 v[92:95], a[36:39], v[100:103], v[92:95]
    s_waitcnt vmcnt(10) lgkmcnt(0)
    s_barrier
    v_mfma_f32_16x16x32_bf16 v[64:67], v[104:107], a[40:43], v[64:67]
    ds_read_b128 a[48:51], v4 offset:57344
    v_mfma_f32_16x16x32_bf16 v[68:71], v[104:107], a[44:47], v[68:71]
    ds_read_b128 a[52:55], v4 offset:59392
    v_add_u32 v6, 0x15000, v6
    ds_read_b64_tr_b16 v[96:97], v6 offset:0
    ds_read_b64_tr_b16 v[98:99], v6 offset:256
    ds_read_b64_tr_b16 v[100:101], v6 offset:1024
    ds_read_b64_tr_b16 v[102:103], v6 offset:1280
    s_add_u32 s52, s43, 6
    s_and_b32 s52, s52, 7
    s_lshl_b32 s53, s52, 7
    s_add_u32 m0, s48, 106496
    s_add_u32 s53, s53, s45
    buffer_load_dwordx4 v8, s[4:7], s53 offen lds
    v_mfma_f32_16x16x32_bf16 v[72:75], v[108:111], a[40:43], v[72:75]
    v_add_u32 v7, 0x15000, v7
    ds_read_b64_tr_b16 v[104:105], v7 offset:0
    v_mfma_f32_16x16x32_bf16 v[76:79], v[108:111], a[44:47], v[76:79]
    ds_read_b64_tr_b16 v[106:107], v7 offset:256
    v_mfma_f32_16x16x32_bf16 v[80:83], a[40:43], v[112:115], v[80:83]
    v_add_u32 v12, 0x15000, v12
    ds_read_b64_tr_b16 v[108:109], v12 offset:0
    v_mfma_f32_16x16x32_bf16 v[88:91], a[44:47], v[112:115], v[88:91]
    ds_read_b64_tr_b16 v[110:111], v12 offset:256
    s_add_u32 m0, s48, 107520
    s_mul_i32 s54, s52, 196608
    buffer_load_dwordx4 v9, s[4:7], s53 offen lds
    v_mfma_f32_16x16x32_bf16 v[84:87], a[40:43], v[116:119], v[84:87]
    ds_read_b128 a[56:59], v5 offset:57344
    v_mfma_f32_16x16x32_bf16 v[92:95], a[44:47], v[116:119], v[92:95]
    ds_read_b128 a[60:63], v5 offset:59392
    ds_read_b64_tr_b16 v[112:113], v6 offset:6144
    ds_read_b64_tr_b16 v[114:115], v6 offset:6400
    s_waitcnt lgkmcnt(10)
    v_mfma_f32_16x16x32_bf16 v[64:67], v[96:99], a[48:51], v[64:67]
    ds_read_b64_tr_b16 v[116:117], v6 offset:7168
    v_mfma_f32_16x16x32_bf16 v[68:71], v[96:99], a[52:55], v[68:71]
    ds_read_b64_tr_b16 v[118:119], v6 offset:7424
    s_add_u32 m0, s49, 122880
    s_add_u32 s54, s54, s46
    buffer_load_dwordx4 v10, s[8:11], s54 offen offset:0 lds
    s_waitcnt lgkmcnt(10)
    v_mfma_f32_16x16x32_bf16 v[72:75], v[100:103], a[48:51], v[72:75]
    ds_read_b64_tr_b16 v[96:97], v7 offset:6144
    v_mfma_f32_16x16x32_bf16 v[76:79], v[100:103], a[52:55], v[76:79]
    ds_read_b64_tr_b16 v[98:99], v7 offset:6400
    s_waitcnt lgkmcnt(10)
    v_mfma_f32_16x16x32_bf16 v[80:83], a[48:51], v[104:107], v[80:83]
    ds_read_b64_tr_b16 v[100:101], v12 offset:6144
    v_mfma_f32_16x16x32_bf16 v[88:91], a[52:55], v[104:107], v[88:91]
    ds_read_b64_tr_b16 v[102:103], v12 offset:6400
    buffer_load_dwordx4 v10, s[8:11], s54 offen offset:1024 lds
    s_waitcnt lgkmcnt(10)
    v_mfma_f32_16x16x32_bf16 v[84:87], a[48:51], v[108:111], v[84:87]
    v_mfma_f32_16x16x32_bf16 v[92:95], a[52:55], v[108:111], v[92:95]
    s_waitcnt vmcnt(10) lgkmcnt(0)
    s_barrier
    v_mfma_f32_16x16x32_bf16 v[64:67], v[112:115], a[56:59], v[64:67]
    v_add_u32 v4, 0xffff9000, v4
    ds_read_b128 a[64:67], v4 offset:0
    v_mfma_f32_16x16x32_bf16 v[68:71], v[112:115], a[60:63], v[68:71]
    ds_read_b128 a[68:71], v4 offset:2048
    v_add_u32 v6, 0xfffeb000, v6
    ds_read_b64_tr_b16 v[104:105], v6 offset:0
    ds_read_b64_tr_b16 v[106:107], v6 offset:256
    ds_read_b64_tr_b16 v[108:109], v6 offset:1024
    ds_read_b64_tr_b16 v[110:111], v6 offset:1280
    s_add_u32 s52, s43, 7
    s_and_b32 s52, s52, 7
    s_lshl_b32 s53, s52, 7
    s_add_u32 m0, s48, 135168
    s_add_u32 s53, s53, s45
    buffer_load_dwordx4 v8, s[4:7], s53 offen lds
    v_mfma_f32_16x16x32_bf16 v[72:75], v[116:119], a[56:59], v[72:75]
    v_add_u32 v7, 0xfffeb000, v7
    ds_read_b64_tr_b16 v[112:113], v7 offset:0
    v_mfma_f32_16x16x32_bf16 v[76:79], v[116:119], a[60:63], v[76:79]
    ds_read_b64_tr_b16 v[114:115], v7 offset:256
    v_mfma_f32_16x16x32_bf16 v[80:83], a[56:59], v[96:99], v[80:83]
    v_add_u32 v12, 0xfffeb000, v12
    ds_read_b64_tr_b16 v[116:117], v12 offset:0
    v_mfma_f32_16x16x32_bf16 v[88:91], a[60:63], v[96:99], v[88:91]
    ds_read_b64_tr_b16 v[118:119], v12 offset:256
    s_add_u32 m0, s48, 136192
    s_mul_i32 s54, s52, 196608
    buffer_load_dwordx4 v9, s[4:7], s53 offen lds
    v_mfma_f32_16x16x32_bf16 v[84:87], a[56:59], v[100:103], v[84:87]
    v_add_u32 v5, 0xffff9000, v5
    ds_read_b128 a[72:75], v5 offset:0
    v_mfma_f32_16x16x32_bf16 v[92:95], a[60:63], v[100:103], v[92:95]
    ds_read_b128 a[76:79], v5 offset:2048
    ds_read_b64_tr_b16 v[96:97], v6 offset:6144
    ds_read_b64_tr_b16 v[98:99], v6 offset:6400
    s_waitcnt lgkmcnt(10)
    v_mfma_f32_16x16x32_bf16 v[64:67], v[104:107], a[64:67], v[64:67]
    ds_read_b64_tr_b16 v[100:101], v6 offset:7168
    v_mfma_f32_16x16x32_bf16 v[68:71], v[104:107], a[68:71], v[68:71]
    ds_read_b64_tr_b16 v[102:103], v6 offset:7424
    s_add_u32 m0, s49, 151552
    s_add_u32 s54, s54, s46
    buffer_load_dwordx4 v10, s[8:11], s54 offen offset:0 lds
    s_waitcnt lgkmcnt(10)
    v_mfma_f32_16x16x32_bf16 v[72:75], v[108:111], a[64:67], v[72:75]
    ds_read_b64_tr_b16 v[104:105], v7 offset:6144
    v_mfma_f32_16x16x32_bf16 v[76:79], v[108:111], a[68:71], v[76:79]
    ds_read_b64_tr_b16 v[106:107], v7 offset:6400
    s_waitcnt lgkmcnt(10)
    v_mfma_f32_16x16x32_bf16 v[80:83], a[64:67], v[112:115], v[80:83]
    ds_read_b64_tr_b16 v[108:109], v12 offset:6144
    v_mfma_f32_16x16x32_bf16 v[88:91], a[68:71], v[112:115], v[88:91]
    ds_read_b64_tr_b16 v[110:111], v12 offset:6400
    buffer_load_dwordx4 v10, s[8:11], s54 offen offset:1024 lds
    s_waitcnt lgkmcnt(10)
    v_mfma_f32_16x16x32_bf16 v[84:87], a[64:67], v[116:119], v[84:87]
    v_mfma_f32_16x16x32_bf16 v[92:95], a[68:71], v[116:119], v[92:95]
    s_waitcnt vmcnt(8) lgkmcnt(0)
    s_barrier
    v_mfma_f32_16x16x32_bf16 v[64:67], v[96:99], a[72:75], v[64:67]
    ds_read_b128 a[80:83], v4 offset:28672
    v_mfma_f32_16x16x32_bf16 v[68:71], v[96:99], a[76:79], v[68:71]
    ds_read_b128 a[84:87], v4 offset:30720
    ds_read_b64_tr_b16 v[112:113], v6 offset:28672
    ds_read_b64_tr_b16 v[114:115], v6 offset:28928
    ds_read_b64_tr_b16 v[116:117], v6 offset:29696
    ds_read_b64_tr_b16 v[118:119], v6 offset:29952
    s_add_u32 s52, s43, 8
    s_and_b32 s52, s52, 7
    s_mul_i32 s54, s52, 176128
    s_add_u32 m0, s50, 53248
    s_add_u32 s54, s54, s47
    buffer_load_dwordx4 v13, s[12:15], s54 offen offset:0 lds
    ds_read_b128 v[8:11], v15 offset:11264
    v_mfma_f32_16x16x32_bf16 v[72:75], v[100:103], a[72:75], v[72:75]
    ds_read_b64_tr_b16 v[96:97], v7 offset:28672
    v_mfma_f32_16x16x32_bf16 v[76:79], v[100:103], a[76:79], v[76:79]
    ds_read_b64_tr_b16 v[98:99], v7 offset:28928
    v_mfma_f32_16x16x32_bf16 v[80:83], a[72:75], v[104:107], v[80:83]
    ds_read_b64_tr_b16 v[100:101], v12 offset:28672
    v_mfma_f32_16x16x32_bf16 v[88:91], a[76:79], v[104:107], v[88:91]
    ds_read_b64_tr_b16 v[102:103], v12 offset:28928
    s_add_u32 m0, s50, 55232
    s_nop 0
    buffer_load_dwordx4 v13, s[12:15], s54 offen offset:64 lds
    v_mfma_f32_16x16x32_bf16 v[84:87], a[72:75], v[108:111], v[84:87]
    ds_read_b128 a[88:91], v5 offset:28672
    v_mfma_f32_16x16x32_bf16 v[92:95], a[76:79], v[108:111], v[92:95]
    ds_read_b128 a[92:95], v5 offset:30720
    ds_read_b64_tr_b16 v[104:105], v6 offset:34816
    ds_read_b64_tr_b16 v[106:107], v6 offset:35072
    s_waitcnt lgkmcnt(11)
    v_mfma_f32_16x16x32_bf16 v[64:67], v[112:115], a[80:83], v[64:67]
    ds_read_b64_tr_b16 v[108:109], v6 offset:35840
    v_mfma_f32_16x16x32_bf16 v[68:71], v[112:115], a[84:87], v[68:71]
    ds_read_b64_tr_b16 v[110:111], v6 offset:36096
    s_add_u32 m0, s50, 57216
    s_nop 0
    buffer_load_dwordx4 v14, s[12:15], s54 offen offset:128 lds
    s_waitcnt lgkmcnt(11)
    v_mfma_f32_16x16x32_bf16 v[72:75], v[116:119], a[80:83], v[72:75]
    ds_read_b64_tr_b16 v[112:113], v7 offset:34816
    v_mfma_f32_16x16x32_bf16 v[76:79], v[116:119], a[84:87], v[76:79]
    ds_read_b64_tr_b16 v[114:115], v7 offset:35072
    s_waitcnt lgkmcnt(10)
    v_mfma_f32_16x16x32_bf16 v[80:83], a[80:83], v[96:99], v[80:83]
    ds_read_b64_tr_b16 v[116:117], v12 offset:34816
    v_mfma_f32_16x16x32_bf16 v[88:91], a[84:87], v[96:99], v[88:91]
    ds_read_b64_tr_b16 v[118:119], v12 offset:35072
    s_waitcnt lgkmcnt(10)
    v_mfma_f32_16x16x32_bf16 v[84:87], a[80:83], v[100:103], v[84:87]
    v_mfma_f32_16x16x32_bf16 v[92:95], a[84:87], v[100:103], v[92:95]
    s_waitcnt vmcnt(7) lgkmcnt(0)
    s_barrier
    v_mfma_f32_16x16x32_bf16 v[64:67], v[104:107], a[88:91], v[64:67]
    ds_read_b128 a[96:99], v4 offset:57344
    v_mfma_f32_16x16x32_bf16 v[68:71], v[104:107], a[92:95], v[68:71]
    ds_read_b128 a[100:103], v4 offset:59392
    ds_read_b64_tr_b16 v[96:97], v6 offset:57344
    ds_read_b64_tr_b16 v[98:99], v6 offset:57600
    ds_read_b64_tr_b16 v[100:101], v6 offset:58368
    ds_read_b64_tr_b16 v[102:103], v6 offset:58624
    s_add_u32 s52, s43, 9
    s_and_b32 s52, s52, 7
    s_mul_i32 s54, s52, 176128
    s_add_u32 m0, s50, 81920
    s_add_u32 s54, s54, s47
    buffer_load_dwordx4 v13, s[12:15], s54 offen offset:0 lds
    s_lshl_b32 s3, s42, 11
    v_add_u32 v9, s3, v9
    v_mfma_f32_16x16x32_bf16 v[72:75], v[108:111], a[88:91], v[72:75]
    ds_read_b64_tr_b16 v[104:105], v7 offset:57344
    v_mfma_f32_16x16x32_bf16 v[76:79], v[108:111], a[92:95], v[76:79]
    ds_read_b64_tr_b16 v[106:107], v7 offset:57600
    v_mfma_f32_16x16x32_bf16 v[80:83], a[88:91], v[112:115], v[80:83]
    ds_read_b64_tr_b16 v[108:109], v12 offset:57344
    v_mfma_f32_16x16x32_bf16 v[88:91], a[92:95], v[112:115], v[88:91]
    ds_read_b64_tr_b16 v[110:111], v12 offset:57600
    s_add_u32 m0, s50, 83904
    s_nop 0
    buffer_load_dwordx4 v13, s[12:15], s54 offen offset:64 lds
    v_mfma_f32_16x16x32_bf16 v[84:87], a[88:91], v[116:119], v[84:87]
    ds_read_b128 a[104:107], v5 offset:57344
    v_mfma_f32_16x16x32_bf16 v[92:95], a[92:95], v[116:119], v[92:95]
    ds_read_b128 a[108:111], v5 offset:59392
    ds_read_b64_tr_b16 v[112:113], v6 offset:63488
    ds_read_b64_tr_b16 v[114:115], v6 offset:63744
    s_waitcnt lgkmcnt(10)
    v_mfma_f32_16x16x32_bf16 v[64:67], v[96:99], a[96:99], v[64:67]
    ds_read_b64_tr_b16 v[116:117], v6 offset:64512
    v_mfma_f32_16x16x32_bf16 v[68:71], v[96:99], a[100:103], v[68:71]
    ds_read_b64_tr_b16 v[118:119], v6 offset:64768
    s_add_u32 m0, s50, 85888
    s_nop 0
    buffer_load_dwordx4 v14, s[12:15], s54 offen offset:128 lds
    s_waitcnt lgkmcnt(10)
    v_mfma_f32_16x16x32_bf16 v[72:75], v[100:103], a[96:99], v[72:75]
    ds_read_b64_tr_b16 v[96:97], v7 offset:63488
    v_mfma_f32_16x16x32_bf16 v[76:79], v[100:103], a[100:103], v[76:79]
    ds_read_b64_tr_b16 v[98:99], v7 offset:63744
    s_waitcnt lgkmcnt(10)
    v_mfma_f32_16x16x32_bf16 v[80:83], a[96:99], v[104:107], v[80:83]
    ds_read_b64_tr_b16 v[100:101], v12 offset:63488
    v_mfma_f32_16x16x32_bf16 v[88:91], a[100:103], v[104:107], v[88:91]
    ds_read_b64_tr_b16 v[102:103], v12 offset:63744
    s_waitcnt lgkmcnt(10)
    v_mfma_f32_16x16x32_bf16 v[84:87], a[96:99], v[108:111], v[84:87]
    v_mfma_f32_16x16x32_bf16 v[92:95], a[100:103], v[108:111], v[92:95]
    s_waitcnt vmcnt(6) lgkmcnt(0)
    s_barrier
    v_mfma_f32_16x16x32_bf16 v[64:67], v[112:115], a[104:107], v[64:67]
    v_add_u32 v4, 0x15000, v4
    ds_read_b128 a[112:115], v4 offset:0
    v_mfma_f32_16x16x32_bf16 v[68:71], v[112:115], a[108:111], v[68:71]
    ds_read_b128 a[116:119], v4 offset:2048
    v_add_u32 v6, 0x15000, v6
    ds_read_b64_tr_b16 v[104:105], v6 offset:0
    ds_read_b64_tr_b16 v[106:107], v6 offset:256
    ds_read_b64_tr_b16 v[108:109], v6 offset:1024
    ds_read_b64_tr_b16 v[110:111], v6 offset:1280
    s_add_u32 s52, s43, 10
    s_and_b32 s52, s52, 7
    s_mul_i32 s54, s52, 176128
    s_add_u32 m0, s50, 110592
    s_add_u32 s54, s54, s47
    buffer_load_dwordx4 v13, s[12:15], s54 offen offset:0 lds
    v_mfma_f32_16x16x32_bf16 v[72:75], v[116:119], a[104:107], v[72:75]
    v_add_u32 v7, 0x15000, v7
    ds_read_b64_tr_b16 v[112:113], v7 offset:0
    v_mfma_f32_16x16x32_bf16 v[76:79], v[116:119], a[108:111], v[76:79]
    ds_read_b64_tr_b16 v[114:115], v7 offset:256
    v_mfma_f32_16x16x32_bf16 v[80:83], a[104:107], v[96:99], v[80:83]
    v_add_u32 v12, 0x15000, v12
    ds_read_b64_tr_b16 v[116:117], v12 offset:0
    v_mfma_f32_16x16x32_bf16 v[88:91], a[108:111], v[96:99], v[88:91]
    ds_read_b64_tr_b16 v[118:119], v12 offset:256
    s_add_u32 m0, s50, 112576
    s_nop 0
    buffer_load_dwordx4 v13, s[12:15], s54 offen offset:64 lds
    v_mfma_f32_16x16x32_bf16 v[84:87], a[104:107], v[100:103], v[84:87]
    v_add_u32 v5, 0x15000, v5
    ds_read_b128 a[120:123], v5 offset:0
    v_mfma_f32_16x16x32_bf16 v[92:95], a[108:111], v[100:103], v[92:95]
    ds_read_b128 a[124:127], v5 offset:2048
    ds_read_b64_tr_b16 v[96:97], v6 offset:6144
    ds_read_b64_tr_b16 v[98:99], v6 offset:6400
    s_waitcnt lgkmcnt(10)
    v_mfma_f32_16x16x32_bf16 v[64:67], v[104:107], a[112:115], v[64:67]
    ds_read_b64_tr_b16 v[100:101], v6 offset:7168
    v_mfma_f32_16x16x32_bf16 v[68:71], v[104:107], a[116:119], v[68:71]
    ds_read_b64_tr_b16 v[102:103], v6 offset:7424
    s_add_u32 m0, s50, 114560
    s_nop 0
    buffer_load_dwordx4 v14, s[12:15], s54 offen offset:128 lds
    s_waitcnt lgkmcnt(10)
    v_mfma_f32_16x16x32_bf16 v[72:75], v[108:111], a[112:115], v[72:75]
    ds_read_b64_tr_b16 v[104:105], v7 offset:6144
    v_mfma_f32_16x16x32_bf16 v[76:79], v[108:111], a[116:119], v[76:79]
    ds_read_b64_tr_b16 v[106:107], v7 offset:6400
    s_waitcnt lgkmcnt(10)
    v_mfma_f32_16x16x32_bf16 v[80:83], a[112:115], v[112:115], v[80:83]
    ds_read_b64_tr_b16 v[108:109], v12 offset:6144
    v_mfma_f32_16x16x32_bf16 v[88:91], a[116:119], v[112:115], v[88:91]
    ds_read_b64_tr_b16 v[110:111], v12 offset:6400
    buffer_load_dword v127, off, s[32:35], 0 sc1
    s_waitcnt lgkmcnt(10)
    v_mfma_f32_16x16x32_bf16 v[84:87], a[112:115], v[116:119], v[84:87]
    v_mfma_f32_16x16x32_bf16 v[92:95], a[116:119], v[116:119], v[92:95]
    s_waitcnt vmcnt(7) lgkmcnt(0)
    s_barrier
    v_mfma_f32_16x16x32_bf16 v[64:67], v[96:99], a[120:123], v[64:67]
    ds_read_b64_tr_b16 v[112:113], v2 offset:53248
    v_mfma_f32_16x16x32_bf16 v[68:71], v[96:99], a[124:127], v[68:71]
    ds_read_b64_tr_b16 v[114:115], v2 offset:53504
    ds_read_b64_tr_b16 v[116:117], v2 offset:54272
    ds_read_b64_tr_b16 v[118:119], v2 offset:54528
    s_add_u32 s52, s43, 11
    s_and_b32 s52, s52, 7
    s_mul_i32 s54, s52, 176128
    s_add_u32 m0, s50, 139264
    s_add_u32 s54, s54, s47
    buffer_load_dwordx4 v13, s[12:15], s54 offen offset:0 lds
    v_mfma_f32_16x16x32_bf16 v[72:75], v[100:103], a[120:123], v[72:75]
    ds_read_b64_tr_b16 v[96:97], v2 offset:55296
    v_mfma_f32_16x16x32_bf16 v[76:79], v[100:103], a[124:127], v[76:79]
    ds_read_b64_tr_b16 v[98:99], v2 offset:55552
    v_mfma_f32_16x16x32_bf16 v[80:83], a[120:123], v[104:107], v[80:83]
    ds_read_b64_tr_b16 v[100:101], v2 offset:56320
    v_mfma_f32_16x16x32_bf16 v[88:91], a[124:127], v[104:107], v[88:91]
    ds_read_b64_tr_b16 v[102:103], v2 offset:56576
    s_add_u32 m0, s50, 141248
    s_nop 0
    buffer_load_dwordx4 v13, s[12:15], s54 offen offset:64 lds
    v_mfma_f32_16x16x32_bf16 v[84:87], a[120:123], v[108:111], v[84:87]
    ds_read_b64_tr_b16 v[104:105], v2 offset:57344
    v_mfma_f32_16x16x32_bf16 v[92:95], a[124:127], v[108:111], v[92:95]
    ds_read_b64_tr_b16 v[106:107], v2 offset:57600
    s_waitcnt lgkmcnt(8)
    v_mfma_f32_16x16x32_bf16 v[16:19], v[112:115], a[0:3], 0
    ds_read_b64_tr_b16 v[108:109], v2 offset:58368
    v_mfma_f32_16x16x32_bf16 v[20:23], v[112:115], a[4:7], 0
    ds_read_b64_tr_b16 v[110:111], v2 offset:58624
    s_add_u32 m0, s50, 143232
    s_nop 0
    buffer_load_dwordx4 v14, s[12:15], s54 offen offset:128 lds
    s_waitcnt lgkmcnt(8)
    v_mfma_f32_16x16x32_bf16 v[24:27], v[116:119], a[0:3], 0
    v_add_u32 v2, 0x10000, v2
    ds_read_b64_tr_b16 v[112:113], v2 offset:0
    v_mfma_f32_16x16x32_bf16 v[28:31], v[116:119], a[4:7], 0
    ds_read_b64_tr_b16 v[114:115], v2 offset:256
    s_waitcnt lgkmcnt(8)
    v_mfma_f32_16x16x32_bf16 v[32:35], v[96:99], a[0:3], 0
    ds_read_b64_tr_b16 v[116:117], v2 offset:1024
    v_mfma_f32_16x16x32_bf16 v[36:39], v[96:99], a[4:7], 0
    ds_read_b64_tr_b16 v[118:119], v2 offset:1280
    v_cvt_pk_bf16_f32 v72, v72, v73
    v_cvt_pk_bf16_f32 v73, v74, v75
    v_cvt_pk_bf16_f32 v74, v76, v77
    s_waitcnt lgkmcnt(8)
    v_mfma_f32_16x16x32_bf16 v[40:43], v[100:103], a[0:3], 0
    ds_read_b64_tr_b16 v[96:97], v2 offset:2048
    v_mfma_f32_16x16x32_bf16 v[44:47], v[100:103], a[4:7], 0
    ds_read_b64_tr_b16 v[98:99], v2 offset:2304
    v_cvt_pk_bf16_f32 v75, v78, v79
    s_sub_u32 s3, 6144, s51
    v_add_u32 v12, s3, v15
    v_permlane16_swap_b32 v72, v74
    v_permlane16_swap_b32 v73, v75
    s_waitcnt lgkmcnt(8)
    v_mfma_f32_16x16x32_bf16 v[48:51], v[104:107], a[0:3], 0
    ds_read_b64_tr_b16 v[100:101], v2 offset:3072
    v_mfma_f32_16x16x32_bf16 v[52:55], v[104:107], a[4:7], 0
    ds_read_b64_tr_b16 v[102:103], v2 offset:3328
    buffer_store_dwordx4 v[72:75], v15, s[24:27], s56 offen offset:0 sc1
    v_cvt_pk_bf16_f32 v80, v80, v81
    v_cvt_pk_bf16_f32 v81, v82, v83
    s_waitcnt lgkmcnt(8)
    v_mfma_f32_16x16x32_bf16 v[56:59], v[108:111], a[0:3], 0
    ds_read_b64_tr_b16 v[104:105], v2 offset:4096
    v_mfma_f32_16x16x32_bf16 v[60:63], v[108:111], a[4:7], 0
    ds_read_b64_tr_b16 v[106:107], v2 offset:4352
    v_cvt_pk_bf16_f32 v82, v84, v85
    v_cvt_pk_bf16_f32 v83, v86, v87
    s_nop 0
    v_permlane16_swap_b32 v80, v82
    v_permlane16_swap_b32 v81, v83
    s_waitcnt lgkmcnt(8)
    v_mfma_f32_16x16x32_bf16 v[16:19], v[112:115], a[8:11], v[16:19]
    ds_read_b64_tr_b16 v[108:109], v2 offset:5120
    v_mfma_f32_16x16x32_bf16 v[20:23], v[112:115], a[12:15], v[20:23]
    ds_read_b64_tr_b16 v[110:111], v2 offset:5376
    v_permlane32_swap_b32 v80, v82
    v_permlane32_swap_b32 v81, v83
    buffer_store_dwordx4 v[80:83], v15, s[24:27], s56 offen offset:2048 sc1
    v_cvt_pk_bf16_f32 v84, v88, v89
    s_waitcnt lgkmcnt(8)
    v_mfma_f32_16x16x32_bf16 v[24:27], v[116:119], a[8:11], v[24:27]
    v_mfma_f32_16x16x32_bf16 v[28:31], v[116:119], a[12:15], v[28:31]
    s_waitcnt vmcnt(9) lgkmcnt(0)
    s_barrier
    v_mfma_f32_16x16x32_bf16 v[32:35], v[96:99], a[8:11], v[32:35]
    ds_read_b64_tr_b16 v[112:113], v2 offset:16384
    v_mfma_f32_16x16x32_bf16 v[36:39], v[96:99], a[12:15], v[36:39]
    ds_read_b64_tr_b16 v[114:115], v2 offset:16640
    ds_read_b64_tr_b16 v[116:117], v2 offset:17408
    ds_read_b64_tr_b16 v[118:119], v2 offset:17664
    v_cvt_pk_bf16_f32 v85, v90, v91
    v_cvt_pk_bf16_f32 v86, v92, v93
    v_cvt_pk_bf16_f32 v87, v94, v95
    v_mfma_f32_16x16x32_bf16 v[40:43], v[100:103], a[8:11], v[40:43]
    ds_read_b64_tr_b16 v[96:97], v2 offset:18432
    v_mfma_f32_16x16x32_bf16 v[44:47], v[100:103], a[12:15], v[44:47]
    ds_read_b64_tr_b16 v[98:99], v2 offset:18688
    s_add_u32 s52, s43, 12
    s_and_b32 s52, s52, 7
    s_mul_i32 s54, s52, 176128
    s_add_u32 m0, s50, 53248
    s_add_u32 s54, s54, s47
    buffer_load_dwordx4 v13, s[12:15], s54 offen offset:0 lds
    v_permlane16_swap_b32 v84, v86
    v_permlane16_swap_b32 v85, v87
    s_nop 0
    v_permlane32_swap_b32 v84, v86
    v_permlane32_swap_b32 v85, v87
    buffer_store_dwordx4 v[84:87], v15, s[24:27], s56 offen offset:3072 sc1
    v_mfma_f32_16x16x32_bf16 v[48:51], v[104:107], a[8:11], v[48:51]
    ds_read_b64_tr_b16 v[100:101], v2 offset:19456
    v_mfma_f32_16x16x32_bf16 v[52:55], v[104:107], a[12:15], v[52:55]
    ds_read_b64_tr_b16 v[102:103], v2 offset:19712
    ds_write_b128 v12, v[72:75]
    s_sub_u32 s3, 30816, s61
    v_add_u32 v125, s3, v15
    ds_write_b128 v125, v[80:83] offset:0
    v_mfma_f32_16x16x32_bf16 v[56:59], v[108:111], a[8:11], v[56:59]
    ds_read_b64_tr_b16 v[104:105], v2 offset:20480
    v_mfma_f32_16x16x32_bf16 v[60:63], v[108:111], a[12:15], v[60:63]
    ds_read_b64_tr_b16 v[106:107], v2 offset:20736
    ds_write_b128 v125, v[84:87] offset:1040
    s_mov_b32 s4, 0x3eb8aa3b
    s_mov_b32 s5, 0x3eb8aa3b
    v_pk_mul_f32 v[64:65], v[64:65], s[4:5]
    s_waitcnt lgkmcnt(11)
    v_mfma_f32_16x16x32_bf16 v[16:19], v[112:115], a[16:19], v[16:19]
    ds_read_b64_tr_b16 v[108:109], v2 offset:21504
    v_mfma_f32_16x16x32_bf16 v[20:23], v[112:115], a[20:23], v[20:23]
    ds_read_b64_tr_b16 v[110:111], v2 offset:21760
    s_add_u32 m0, s50, 55232
    s_nop 0
    buffer_load_dwordx4 v13, s[12:15], s54 offen offset:64 lds
    v_pk_mul_f32 v[66:67], v[66:67], s[4:5]
    v_pk_mul_f32 v[68:69], v[68:69], s[4:5]
    v_pk_mul_f32 v[70:71], v[70:71], s[4:5]
    s_waitcnt lgkmcnt(11)
    v_mfma_f32_16x16x32_bf16 v[24:27], v[116:119], a[16:19], v[24:27]
    ds_read_b64_tr_b16 v[112:113], v2 offset:28672
    v_mfma_f32_16x16x32_bf16 v[28:31], v[116:119], a[20:23], v[28:31]
    ds_read_b64_tr_b16 v[114:115], v2 offset:28928
    v_cvt_pk_bf16_f32 v120, v64, v65
    v_cvt_pk_bf16_f32 v121, v66, v67
    v_cvt_pk_bf16_f32 v122, v68, v69
    s_waitcnt lgkmcnt(11)
    v_mfma_f32_16x16x32_bf16 v[32:35], v[96:99], a[16:19], v[32:35]
    ds_read_b64_tr_b16 v[116:117], v2 offset:29696
    v_mfma_f32_16x16x32_bf16 v[36:39], v[96:99], a[20:23], v[36:39]
    ds_read_b64_tr_b16 v[118:119], v2 offset:29952
    v_cvt_pk_bf16_f32 v123, v70, v71
    v_permlane16_swap_b32 v120, v122
    s_nop 0
    v_permlane16_swap_b32 v121, v123
    v_and_b32 v125, 15, v0
    s_lshl_b32 s3, s42, 7
    v_lshl_add_u32 v125, v125, 3, s3
    ds_read_b64 v[68:69], v125 offset:18432
    s_waitcnt lgkmcnt(12)
    v_mfma_f32_16x16x32_bf16 v[40:43], v[100:103], a[16:19], v[40:43]
    ds_read_b64_tr_b16 v[96:97], v2 offset:30720
    v_mfma_f32_16x16x32_bf16 v[44:47], v[100:103], a[20:23], v[44:47]
    ds_read_b64_tr_b16 v[98:99], v2 offset:30976
    s_add_u32 m0, s50, 57216
    s_nop 0
    buffer_load_dwordx4 v14, s[12:15], s54 offen offset:128 lds
    ds_read_b128 v[4:7], v15 offset:10240
    s_waitcnt lgkmcnt(11)
    v_mfma_f32_16x16x32_bf16 v[48:51], v[104:107], a[16:19], v[48:51]
    ds_read_b64_tr_b16 v[100:101], v2 offset:31744
    v_mfma_f32_16x16x32_bf16 v[52:55], v[104:107], a[20:23], v[52:55]
    ds_read_b64_tr_b16 v[102:103], v2 offset:32000
    s_waitcnt lgkmcnt(10)
    v_mfma_f32_16x16x32_bf16 v[56:59], v[108:111], a[16:19], v[56:59]
    ds_read_b64_tr_b16 v[104:105], v2 offset:32768
    v_mfma_f32_16x16x32_bf16 v[60:63], v[108:111], a[20:23], v[60:63]
    ds_read_b64_tr_b16 v[106:107], v2 offset:33024
    s_waitcnt lgkmcnt(10)
    v_mfma_f32_16x16x32_bf16 v[16:19], v[112:115], a[24:27], v[16:19]
    ds_read_b64_tr_b16 v[108:109], v2 offset:33792
    v_mfma_f32_16x16x32_bf16 v[20:23], v[112:115], a[28:31], v[20:23]
    ds_read_b64_tr_b16 v[110:111], v2 offset:34048
    s_waitcnt lgkmcnt(10)
    v_mfma_f32_16x16x32_bf16 v[24:27], v[116:119], a[24:27], v[24:27]
    v_mfma_f32_16x16x32_bf16 v[28:31], v[116:119], a[28:31], v[28:31]
    s_waitcnt vmcnt(10) lgkmcnt(0)
    s_barrier
    v_mfma_f32_16x16x32_bf16 v[32:35], v[96:99], a[24:27], v[32:35]
    ds_read_b64_tr_b16 v[112:113], v2 offset:45056
    v_mfma_f32_16x16x32_bf16 v[36:39], v[96:99], a[28:31], v[36:39]
    ds_read_b64_tr_b16 v[114:115], v2 offset:45312
    ds_read_b64_tr_b16 v[116:117], v2 offset:46080
    ds_read_b64_tr_b16 v[118:119], v2 offset:46336
    ds_read_b128 v[88:91], v15 offset:8192
    ds_read_b128 v[92:95], v15 offset:9216
    v_mfma_f32_16x16x32_bf16 v[40:43], v[100:103], a[24:27], v[40:43]
    ds_read_b64_tr_b16 v[96:97], v2 offset:47104
    v_mfma_f32_16x16x32_bf16 v[44:47], v[100:103], a[28:31], v[44:47]
    ds_read_b64_tr_b16 v[98:99], v2 offset:47360
    s_waitcnt vmcnt(2)
    v_cmp_eq_u32 vcc, 0, v127
    s_cbranch_vccz L_ok_1001
    s_mov_b32 s63, 0x40000
L_spin_1002:
    s_sub_u32 s63, s63, 1
    s_cbranch_scc1 L_ok_1001
    s_sleep 1
    buffer_load_dword v127, off, s[32:35], 0 sc1
    s_waitcnt vmcnt(0)
    v_cmp_eq_u32 vcc, 0, v127
    s_cbranch_vccnz L_spin_1002
L_ok_1001:
    s_mov_b64 exec, 1
    buffer_store_dword v127, off, s[24:27], s0 sc1
    s_mov_b64 exec, -1
    s_mov_b32 s4, 0x3fb8aa3b
    s_mov_b32 s5, 0x3fb8aa3b
    v_pk_mul_f32 v[68:69], v[68:69], s[4:5]
    s_mov_b32 s4, 0xffff0000
    s_mov_b32 s5, 0xffff0000
    v_cndmask_b32_e64 v3, v68, v69, s[4:5]
    v_exp_f32 v68, v68
    v_mfma_f32_16x16x32_bf16 v[48:51], v[104:107], a[24:27], v[48:51]
    ds_read_b64_tr_b16 v[100:101], v2 offset:48128
    v_mfma_f32_16x16x32_bf16 v[52:55], v[104:107], a[28:31], v[52:55]
    ds_read_b64_tr_b16 v[102:103], v2 offset:48384
    v_exp_f32 v69, v69
    v_exp_f32_e64 v3, -v3
    v_add_f32 v68, 1.0, v68
    v_mfma_f32_16x16x32_bf16 v[56:59], v[108:111], a[24:27], v[56:59]
    ds_read_b64_tr_b16 v[104:105], v2 offset:49152
    v_mfma_f32_16x16x32_bf16 v[60:63], v[108:111], a[28:31], v[60:63]
    ds_read_b64_tr_b16 v[106:107], v2 offset:49408
    v_add_f32 v69, 1.0, v69
    v_add_f32 v3, 1.0, v3
    v_min_f32 v68, 0x7e800000, v68
    s_waitcnt lgkmcnt(10)
    v_mfma_f32_16x16x32_bf16 v[16:19], v[112:115], a[32:35], v[16:19]
    ds_read_b64_tr_b16 v[108:109], v2 offset:50176
    v_mfma_f32_16x16x32_bf16 v[20:23], v[112:115], a[36:39], v[20:23]
    ds_read_b64_tr_b16 v[110:111], v2 offset:50432
    s_add_u32 s52, s43, 13
    s_and_b32 s52, s52, 7
    s_mul_i32 s54, s52, 176128
    s_add_u32 m0, s50, 81920
    s_add_u32 s54, s54, s47
    buffer_load_dwordx4 v13, s[12:15], s54 offen offset:0 lds
    v_min_f32 v69, 0x7e800000, v69
    s_waitcnt lgkmcnt(10)
    v_mfma_f32_16x16x32_bf16 v[24:27], v[116:119], a[32:35], v[24:27]
    ds_read_b64_tr_b16 v[112:113], v2 offset:57344
    v_mfma_f32_16x16x32_bf16 v[28:31], v[116:119], a[36:39], v[28:31]
    ds_read_b64_tr_b16 v[114:115], v2 offset:57600
    v_rcp_f32 v3, v3
    s_waitcnt lgkmcnt(8)
    v_mfma_f32_16x16x32_bf16 v[32:35], v[96:99], a[32:35], v[32:35]
    ds_read_b64_tr_b16 v[116:117], v2 offset:58368
    v_mfma_f32_16x16x32_bf16 v[36:39], v[96:99], a[36:39], v[36:39]
    ds_read_b64_tr_b16 v[118:119], v2 offset:58624
    s_mov_b32 s4, 0xbfb8aa3b
    s_mov_b32 s5, 0xbfb8aa3b
    s_waitcnt lgkmcnt(8)
    v_mfma_f32_16x16x32_bf16 v[40:43], v[100:103], a[32:35], v[40:43]
    ds_read_b64_tr_b16 v[96:97], v2 offset:59392
    v_mfma_f32_16x16x32_bf16 v[44:47], v[100:103], a[36:39], v[44:47]
    ds_read_b64_tr_b16 v[98:99], v2 offset:59648
    s_add_u32 m0, s50, 83904
    s_nop 0
    buffer_load_dwordx4 v13, s[12:15], s54 offen offset:64 lds
    s_waitcnt lgkmcnt(8)
    v_mfma_f32_16x16x32_bf16 v[48:51], v[104:107], a[32:35], v[48:51]
    ds_read_b64_tr_b16 v[100:101], v2 offset:60416
    v_mfma_f32_16x16x32_bf16 v[52:55], v[104:107], a[36:39], v[52:55]
    ds_read_b64_tr_b16 v[102:103], v2 offset:60672
    s_waitcnt lgkmcnt(8)
    v_mfma_f32_16x16x32_bf16 v[56:59], v[108:111], a[32:35], v[56:59]
    ds_read_b64_tr_b16 v[104:105], v2 offset:61440
    v_mfma_f32_16x16x32_bf16 v[60:63], v[108:111], a[36:39], v[60:63]
    ds_read_b64_tr_b16 v[106:107], v2 offset:61696
    s_waitcnt lgkmcnt(8)
    v_mfma_f32_16x16x32_bf16 v[16:19], v[112:115], a[40:43], v[16:19]
    ds_read_b64_tr_b16 v[108:109], v2 offset:62464
    v_mfma_f32_16x16x32_bf16 v[20:23], v[112:115], a[44:47], v[20:23]
    ds_read_b64_tr_b16 v[110:111], v2 offset:62720
    s_add_u32 m0, s50, 85888
    s_nop 0
    buffer_load_dwordx4 v14, s[12:15], s54 offen offset:128 lds
    s_waitcnt lgkmcnt(8)
    v_mfma_f32_16x16x32_bf16 v[24:27], v[116:119], a[40:43], v[24:27]
    v_mfma_f32_16x16x32_bf16 v[28:31], v[116:119], a[44:47], v[28:31]
    s_waitcnt lgkmcnt(0)
    s_barrier
    v_mfma_f32_16x16x32_bf16 v[32:35], v[96:99], a[40:43], v[32:35]
    v_add_u32 v2, 0x12000, v2
    ds_read_b64_tr_b16 v[112:113], v2 offset:0
    v_mfma_f32_16x16x32_bf16 v[36:39], v[96:99], a[44:47], v[36:39]
    ds_read_b64_tr_b16 v[114:115], v2 offset:256
    ds_read_b64_tr_b16 v[116:117], v2 offset:1024
    ds_read_b64_tr_b16 v[118:119], v2 offset:1280
    s_lshl_b32 s3, s62, 19
    s_add_u32 s62, s62, 1
    s_cmp_eq_u32 s62, 3
    s_cselect_b32 s62, 0, s62
    buffer_load_dword v124, v9, s[16:19], s3 offen
    v_add_u32 v4, s51, v4
    v_mfma_f32_16x16x32_bf16 v[40:43], v[100:103], a[40:43], v[40:43]
    ds_read_b64_tr_b16 v[96:97], v2 offset:2048
    v_mfma_f32_16x16x32_bf16 v[44:47], v[100:103], a[44:47], v[44:47]
    ds_read_b64_tr_b16 v[98:99], v2 offset:2304
    s_add_u32 s52, s43, 14
    s_and_b32 s52, s52, 7
    s_mul_i32 s54, s52, 176128
    s_add_u32 m0, s50, 110592
    s_add_u32 s54, s54, s47
    buffer_load_dwordx4 v13, s[12:15], s54 offen offset:0 lds
    v_subrev_u32 v5, s61, v5
    v_mfma_f32_16x16x32_bf16 v[48:51], v[104:107], a[40:43], v[48:51]
    ds_read_b64_tr_b16 v[100:101], v2 offset:3072
    v_mfma_f32_16x16x32_bf16 v[52:55], v[104:107], a[44:47], v[52:55]
    ds_read_b64_tr_b16 v[102:103], v2 offset:3328
    s_lshl_b32 s3, s42, 10
    v_add_u32 v6, s3, v6
    v_mfma_f32_16x16x32_bf16 v[56:59], v[108:111], a[40:43], v[56:59]
    ds_read_b64_tr_b16 v[104:105], v2 offset:4096
    v_mfma_f32_16x16x32_bf16 v[60:63], v[108:111], a[44:47], v[60:63]
    ds_read_b64_tr_b16 v[106:107], v2 offset:4352
    s_lshl_b32 s3, s62, 19
    s_add_u32 s62, s62, 1
    s_cmp_eq_u32 s62, 3
    s_cselect_b32 s62, 0, s62
    buffer_load_dword v67, v9, s[16:19], s3 offen
    s_waitcnt lgkmcnt(8)
    v_mfma_f32_16x16x32_bf16 v[16:19], v[112:115], a[48:51], v[16:19]
    ds_read_b64_tr_b16 v[108:109], v2 offset:5120
    v_mfma_f32_16x16x32_bf16 v[20:23], v[112:115], a[52:55], v[20:23]
    ds_read_b64_tr_b16 v[110:111], v2 offset:5376
    s_add_u32 m0, s50, 112576
    s_nop 0
    buffer_load_dwordx4 v13, s[12:15], s54 offen offset:64 lds
    s_waitcnt lgkmcnt(8)
    v_mfma_f32_16x16x32_bf16 v[24:27], v[116:119], a[48:51], v[24:27]
    ds_read_b64_tr_b16 v[112:113], v2 offset:12288
    v_mfma_f32_16x16x32_bf16 v[28:31], v[116:119], a[52:55], v[28:31]
    ds_read_b64_tr_b16 v[114:115], v2 offset:12544
    s_waitcnt lgkmcnt(8)
    v_mfma_f32_16x16x32_bf16 v[32:35], v[96:99], a[48:51], v[32:35]
    ds_read_b64_tr_b16 v[116:117], v2 offset:13312
    v_mfma_f32_16x16x32_bf16 v[36:39], v[96:99], a[52:55], v[36:39]
    ds_read_b64_tr_b16 v[118:119], v2 offset:13568
    s_waitcnt lgkmcnt(8)
    v_mfma_f32_16x16x32_bf16 v[40:43], v[100:103], a[48:51], v[40:43]
    ds_read_b64_tr_b16 v[96:97], v2 offset:14336
    v_mfma_f32_16x16x32_bf16 v[44:47], v[100:103], a[52:55], v[44:47]
    ds_read_b64_tr_b16 v[98:99], v2 offset:14592
    s_add_u32 m0, s50, 114560
    s_nop 0
    buffer_load_dwordx4 v14, s[12:15], s54 offen offset:128 lds
    s_waitcnt lgkmcnt(8)
    v_mfma_f32_16x16x32_bf16 v[48:51], v[104:107], a[48:51], v[48:51]
    ds_read_b64_tr_b16 v[100:101], v2 offset:15360
    v_mfma_f32_16x16x32_bf16 v[52:55], v[104:107], a[52:55], v[52:55]
    ds_read_b64_tr_b16 v[102:103], v2 offset:15616
    s_waitcnt lgkmcnt(8)
    v_mfma_f32_16x16x32_bf16 v[56:59], v[108:111], a[48:51], v[56:59]
    ds_read_b64_tr_b16 v[104:105], v2 offset:16384
    v_mfma_f32_16x16x32_bf16 v[60:63], v[108:111], a[52:55], v[60:63]
    ds_read_b64_tr_b16 v[106:107], v2 offset:16640
    s_waitcnt lgkmcnt(8)
    v_mfma_f32_16x16x32_bf16 v[16:19], v[112:115], a[56:59], v[16:19]
    ds_read_b64_tr_b16 v[108:109], v2 offset:17408
    v_mfma_f32_16x16x32_bf16 v[20:23], v[112:115], a[60:63], v[20:23]
    ds_read_b64_tr_b16 v[110:111], v2 offset:17664
    s_waitcnt lgkmcnt(8)
    v_mfma_f32_16x16x32_bf16 v[24:27], v[116:119], a[56:59], v[24:27]
    v_mfma_f32_16x16x32_bf16 v[28:31], v[116:119], a[60:63], v[28:31]
    s_waitcnt vmcnt(9) lgkmcnt(0)
    s_barrier
    v_mfma_f32_16x16x32_bf16 v[32:35], v[96:99], a[56:59], v[32:35]
    v_add_u32 v2, 0xfffeb000, v2
    ds_read_b64_tr_b16 v[112:113], v2 offset:0
    v_mfma_f32_16x16x32_bf16 v[36:39], v[96:99], a[60:63], v[36:39]
    ds_read_b64_tr_b16 v[114:115], v2 offset:256
    ds_read_b64_tr_b16 v[116:117], v2 offset:1024
    ds_read_b64_tr_b16 v[118:119], v2 offset:1280
    s_lshl_b32 s3, s62, 19
    s_add_u32 s62, s62, 1
    s_cmp_eq_u32 s62, 3
    s_cselect_b32 s62, 0, s62
    buffer_load_dword v67, v9, s[16:19], s3 offen
    v_mfma_f32_16x16x32_bf16 v[40:43], v[100:103], a[56:59], v[40:43]
    ds_read_b64_tr_b16 v[96:97], v2 offset:2048
    v_mfma_f32_16x16x32_bf16 v[44:47], v[100:103], a[60:63], v[44:47]
    ds_read_b64_tr_b16 v[98:99], v2 offset:2304
    v_and_b32 v125, 1, v0
    v_lshlrev_b32 v125, 6, v125
    buffer_load_dword v124, v125, s[24:27], s96 offen sc1
    s_add_u32 s52, s43, 15
    s_and_b32 s52, s52, 7
    s_mul_i32 s54, s52, 176128
    s_add_u32 m0, s50, 139264
    s_add_u32 s54, s54, s47
    buffer_load_dwordx4 v13, s[12:15], s54 offen offset:0 lds
    v_mfma_f32_16x16x32_bf16 v[48:51], v[104:107], a[56:59], v[48:51]
    ds_read_b64_tr_b16 v[100:101], v2 offset:3072
    v_mfma_f32_16x16x32_bf16 v[52:55], v[104:107], a[60:63], v[52:55]
    ds_read_b64_tr_b16 v[102:103], v2 offset:3328
    v_mfma_f32_16x16x32_bf16 v[56:59], v[108:111], a[56:59], v[56:59]
    ds_read_b64_tr_b16 v[104:105], v2 offset:4096
    v_mfma_f32_16x16x32_bf16 v[60:63], v[108:111], a[60:63], v[60:63]
    ds_read_b64_tr_b16 v[106:107], v2 offset:4352
    s_mov_b32 s3, 0
    buffer_load_dword v67, v9, s[20:23], s3 offen
    s_waitcnt lgkmcnt(8)
    v_mfma_f32_16x16x32_bf16 v[16:19], v[112:115], a[64:67], v[16:19]
    ds_read_b64_tr_b16 v[108:109], v2 offset:5120
    v_mfma_f32_16x16x32_bf16 v[20:23], v[112:115], a[68:71], v[20:23]
    ds_read_b64_tr_b16 v[110:111], v2 offset:5376
    s_add_u32 m0, s50, 141248
    s_nop 0
    buffer_load_dwordx4 v13, s[12:15], s54 offen offset:64 lds
    s_waitcnt lgkmcnt(8)
    v_mfma_f32_16x16x32_bf16 v[24:27], v[116:119], a[64:67], v[24:27]
    ds_read_b64_tr_b16 v[112:113], v2 offset:12288
    v_mfma_f32_16x16x32_bf16 v[28:31], v[116:119], a[68:71], v[28:31]
    ds_read_b64_tr_b16 v[114:115], v2 offset:12544
    s_waitcnt lgkmcnt(8)
    v_mfma_f32_16x16x32_bf16 v[32:35], v[96:99], a[64:67], v[32:35]
    ds_read_b64_tr_b16 v[116:117], v2 offset:13312
    v_mfma_f32_16x16x32_bf16 v[36:39], v[96:99], a[68:71], v[36:39]
    ds_read_b64_tr_b16 v[118:119], v2 offset:13568
    s_waitcnt lgkmcnt(8)
    v_mfma_f32_16x16x32_bf16 v[40:43], v[100:103], a[64:67], v[40:43]
    ds_read_b64_tr_b16 v[96:97], v2 offset:14336
    v_mfma_f32_16x16x32_bf16 v[44:47], v[100:103], a[68:71], v[44:47]
    ds_read_b64_tr_b16 v[98:99], v2 offset:14592
    s_add_u32 m0, s50, 143232
    s_nop 0
    buffer_load_dwordx4 v14, s[12:15], s54 offen offset:128 lds
    s_waitcnt lgkmcnt(8)
    v_mfma_f32_16x16x32_bf16 v[48:51], v[104:107], a[64:67], v[48:51]
    ds_read_b64_tr_b16 v[100:101], v2 offset:15360
    v_mfma_f32_16x16x32_bf16 v[52:55], v[104:107], a[68:71], v[52:55]
    ds_read_b64_tr_b16 v[102:103], v2 offset:15616
    s_waitcnt lgkmcnt(8)
    v_mfma_f32_16x16x32_bf16 v[56:59], v[108:111], a[64:67], v[56:59]
    ds_read_b64_tr_b16 v[104:105], v2 offset:16384
    v_mfma_f32_16x16x32_bf16 v[60:63], v[108:111], a[68:71], v[60:63]
    ds_read_b64_tr_b16 v[106:107], v2 offset:16640
    s_waitcnt lgkmcnt(8)
    v_mfma_f32_16x16x32_bf16 v[16:19], v[112:115], a[72:75], v[16:19]
    ds_read_b64_tr_b16 v[108:109], v2 offset:17408
    v_mfma_f32_16x16x32_bf16 v[20:23], v[112:115], a[76:79], v[20:23]
    ds_read_b64_tr_b16 v[110:111], v2 offset:17664
    v_add_u32 v13, 0x2000, v8
    s_add_u32 s3, s97, 0x1000
    v_add_u32 v14, s3, v15
    s_waitcnt lgkmcnt(8)
    v_mfma_f32_16x16x32_bf16 v[24:27], v[116:119], a[72:75], v[24:27]
    v_mfma_f32_16x16x32_bf16 v[28:31], v[116:119], a[76:79], v[28:31]
    s_waitcnt vmcnt(11) lgkmcnt(0)
    s_barrier
    v_mfma_f32_16x16x32_bf16 v[32:35], v[96:99], a[72:75], v[32:35]
    ds_read_b64_tr_b16 v[112:113], v2 offset:28672
    v_mfma_f32_16x16x32_bf16 v[36:39], v[96:99], a[76:79], v[36:39]
    ds_read_b64_tr_b16 v[114:115], v2 offset:28928
    ds_read_b64_tr_b16 v[116:117], v2 offset:29696
    ds_read_b64_tr_b16 v[118:119], v2 offset:29952
    v_mfma_f32_16x16x32_bf16 v[40:43], v[100:103], a[72:75], v[40:43]
    ds_read_b64_tr_b16 v[96:97], v2 offset:30720
    v_mfma_f32_16x16x32_bf16 v[44:47], v[100:103], a[76:79], v[44:47]
    ds_read_b64_tr_b16 v[98:99], v2 offset:30976
    s_add_u32 m0, s51, 49664
    s_add_u32 s39, s36, 0
    buffer_load_dwordx4 v8, s[16:19], s39 offen lds
    v_mfma_f32_16x16x32_bf16 v[48:51], v[104:107], a[72:75], v[48:51]
    ds_read_b64_tr_b16 v[100:101], v2 offset:31744
    v_mfma_f32_16x16x32_bf16 v[52:55], v[104:107], a[76:79], v[52:55]
    ds_read_b64_tr_b16 v[102:103], v2 offset:32000
    v_mfma_f32_16x16x32_bf16 v[56:59], v[108:111], a[72:75], v[56:59]
    ds_read_b64_tr_b16 v[104:105], v2 offset:32768
    v_mfma_f32_16x16x32_bf16 v[60:63], v[108:111], a[76:79], v[60:63]
    ds_read_b64_tr_b16 v[106:107], v2 offset:33024
    s_waitcnt lgkmcnt(8)
    v_mfma_f32_16x16x32_bf16 v[16:19], v[112:115], a[80:83], v[16:19]
    ds_read_b64_tr_b16 v[108:109], v2 offset:33792
    v_mfma_f32_16x16x32_bf16 v[20:23], v[112:115], a[84:87], v[20:23]
    ds_read_b64_tr_b16 v[110:111], v2 offset:34048
    s_add_u32 m0, s51, 50688
    s_nop 0
    buffer_load_dwordx4 v13, s[16:19], s39 offen lds
    s_waitcnt lgkmcnt(8)
    v_mfma_f32_16x16x32_bf16 v[24:27], v[116:119], a[80:83], v[24:27]
    ds_read_b64_tr_b16 v[112:113], v2 offset:40960
    v_mfma_f32_16x16x32_bf16 v[28:31], v[116:119], a[84:87], v[28:31]
    ds_read_b64_tr_b16 v[114:115], v2 offset:41216
    s_waitcnt lgkmcnt(8)
    v_mfma_f32_16x16x32_bf16 v[32:35], v[96:99], a[80:83], v[32:35]
    ds_read_b64_tr_b16 v[116:117], v2 offset:41984
    v_mfma_f32_16x16x32_bf16 v[36:39], v[96:99], a[84:87], v[36:39]
    ds_read_b64_tr_b16 v[118:119], v2 offset:42240
    s_waitcnt lgkmcnt(8)
    v_mfma_f32_16x16x32_bf16 v[40:43], v[100:103], a[80:83], v[40:43]
    ds_read_b64_tr_b16 v[96:97], v2 offset:43008
    v_mfma_f32_16x16x32_bf16 v[44:47], v[100:103], a[84:87], v[44:47]
    ds_read_b64_tr_b16 v[98:99], v2 offset:43264
    s_waitcnt vmcnt(6)
    v_cmp_ne_u32 vcc, v127, v124
    s_cbranch_vccz L_ok_1003
    s_mov_b32 s63, 0x40000
L_spin_1004:
    s_sub_u32 s63, s63, 1
    s_cbranch_scc1 L_ok_1003
    s_sleep 1
    buffer_load_dword v124, v125, s[24:27], s96 offen sc1
    s_waitcnt vmcnt(0)
    v_cmp_ne_u32 vcc, v127, v124
    s_cbranch_vccnz L_spin_1004
L_ok_1003:
    s_sub_u32 m0, 22528, s51
    v_and_b32 v72, s98, v15
    buffer_load_dwordx4 v72, s[24:27], s99 offen offset:0 sc1 lds
    buffer_load_dwordx4 v72, s[24:27], s99 offen offset:1024 sc1 lds
    s_waitcnt lgkmcnt(8)
    v_mfma_f32_16x16x32_bf16 v[48:51], v[104:107], a[80:83], v[48:51]
    ds_read_b64_tr_b16 v[100:101], v2 offset:44032
    v_mfma_f32_16x16x32_bf16 v[52:55], v[104:107], a[84:87], v[52:55]
    ds_read_b64_tr_b16 v[102:103], v2 offset:44288
    s_waitcnt lgkmcnt(8)
    v_mfma_f32_16x16x32_bf16 v[56:59], v[108:111], a[80:83], v[56:59]
    ds_read_b64_tr_b16 v[104:105], v2 offset:45056
    v_mfma_f32_16x16x32_bf16 v[60:63], v[108:111], a[84:87], v[60:63]
    ds_read_b64_tr_b16 v[106:107], v2 offset:45312
    s_waitcnt lgkmcnt(8)
    v_mfma_f32_16x16x32_bf16 v[16:19], v[112:115], a[88:91], v[16:19]
    ds_read_b64_tr_b16 v[108:109], v2 offset:46080
    v_mfma_f32_16x16x32_bf16 v[20:23], v[112:115], a[92:95], v[20:23]
    ds_read_b64_tr_b16 v[110:111], v2 offset:46336
    s_sub_u32 m0, 45408, s61
    v_add_u32 v73, s40, v15
    buffer_load_dwordx4 v73, s[24:27], s99 offen offset:2048 sc1 lds
    s_sub_u32 m0, 45424, s61
    s_nop 0
    buffer_load_dwordx4 v73, s[24:27], s99 offen offset:3072 sc1 lds
    s_waitcnt lgkmcnt(8)
    v_mfma_f32_16x16x32_bf16 v[24:27], v[116:119], a[88:91], v[24:27]
    v_mfma_f32_16x16x32_bf16 v[28:31], v[116:119], a[92:95], v[28:31]
    s_waitcnt lgkmcnt(0)
    s_barrier
    v_mfma_f32_16x16x32_bf16 v[32:35], v[96:99], a[88:91], v[32:35]
    ds_read_b64_tr_b16 v[112:113], v2 offset:57344
    v_mfma_f32_16x16x32_bf16 v[36:39], v[96:99], a[92:95], v[36:39]
    ds_read_b64_tr_b16 v[114:115], v2 offset:57600
    ds_read_b64_tr_b16 v[116:117], v2 offset:58368
    ds_read_b64_tr_b16 v[118:119], v2 offset:58624
    v_mfma_f32_16x16x32_bf16 v[40:43], v[100:103], a[88:91], v[40:43]
    ds_read_b64_tr_b16 v[96:97], v2 offset:59392
    v_mfma_f32_16x16x32_bf16 v[44:47], v[100:103], a[92:95], v[44:47]
    ds_read_b64_tr_b16 v[98:99], v2 offset:59648
    s_add_u32 m0, s51, 66048
    s_add_u32 s39, s36, 16384
    buffer_load_dwordx4 v8, s[16:19], s39 offen lds
    v_mfma_f32_16x16x32_bf16 v[48:51], v[104:107], a[88:91], v[48:51]
    ds_read_b64_tr_b16 v[100:101], v2 offset:60416
    v_mfma_f32_16x16x32_bf16 v[52:55], v[104:107], a[92:95], v[52:55]
    ds_read_b64_tr_b16 v[102:103], v2 offset:60672
    v_mfma_f32_16x16x32_bf16 v[56:59], v[108:111], a[88:91], v[56:59]
    ds_read_b64_tr_b16 v[104:105], v2 offset:61440
    v_mfma_f32_16x16x32_bf16 v[60:63], v[108:111], a[92:95], v[60:63]
    ds_read_b64_tr_b16 v[106:107], v2 offset:61696
    s_waitcnt lgkmcnt(8)
    v_mfma_f32_16x16x32_bf16 v[16:19], v[112:115], a[96:99], v[16:19]
    ds_read_b64_tr_b16 v[108:109], v2 offset:62464
    v_mfma_f32_16x16x32_bf16 v[20:23], v[112:115], a[100:103], v[20:23]
    ds_read_b64_tr_b16 v[110:111], v2 offset:62720
    s_add_u32 m0, s51, 67072
    s_nop 0
    buffer_load_dwordx4 v13, s[16:19], s39 offen lds
    s_waitcnt lgkmcnt(8)
    v_mfma_f32_16x16x32_bf16 v[24:27], v[116:119], a[96:99], v[24:27]
    v_add_u32 v2, 0x11000, v2
    ds_read_b64_tr_b16 v[112:113], v2 offset:0
    v_mfma_f32_16x16x32_bf16 v[28:31], v[116:119], a[100:103], v[28:31]
    ds_read_b64_tr_b16 v[114:115], v2 offset:256
    s_waitcnt lgkmcnt(8)
    v_mfma_f32_16x16x32_bf16 v[32:35], v[96:99], a[96:99], v[32:35]
    ds_read_b64_tr_b16 v[116:117], v2 offset:1024
    v_mfma_f32_16x16x32_bf16 v[36:39], v[96:99], a[100:103], v[36:39]
    ds_read_b64_tr_b16 v[118:119], v2 offset:1280
    s_waitcnt lgkmcnt(8)
    v_mfma_f32_16x16x32_bf16 v[40:43], v[100:103], a[96:99], v[40:43]
    ds_read_b64_tr_b16 v[96:97], v2 offset:2048
    v_mfma_f32_16x16x32_bf16 v[44:47], v[100:103], a[100:103], v[44:47]
    ds_read_b64_tr_b16 v[98:99], v2 offset:2304
    s_add_u32 m0, s51, 82432
    s_add_u32 s39, s36, 32768
    buffer_load_dwordx4 v8, s[16:19], s39 offen lds
    s_waitcnt lgkmcnt(8)
    v_mfma_f32_16x16x32_bf16 v[48:51], v[104:107], a[96:99], v[48:51]
    ds_read_b64_tr_b16 v[100:101], v2 offset:3072
    v_mfma_f32_16x16x32_bf16 v[52:55], v[104:107], a[100:103], v[52:55]
    ds_read_b64_tr_b16 v[102:103], v2 offset:3328
    s_waitcnt lgkmcnt(8)
    v_mfma_f32_16x16x32_bf16 v[56:59], v[108:111], a[96:99], v[56:59]
    ds_read_b64_tr_b16 v[104:105], v2 offset:4096
    v_mfma_f32_16x16x32_bf16 v[60:63], v[108:111], a[100:103], v[60:63]
    ds_read_b64_tr_b16 v[106:107], v2 offset:4352
    s_waitcnt lgkmcnt(8)
    v_mfma_f32_16x16x32_bf16 v[16:19], v[112:115], a[104:107], v[16:19]
    ds_read_b64_tr_b16 v[108:109], v2 offset:5120
    v_mfma_f32_16x16x32_bf16 v[20:23], v[112:115], a[108:111], v[20:23]
    ds_read_b64_tr_b16 v[110:111], v2 offset:5376
    s_add_u32 m0, s51, 83456
    s_nop 0
    buffer_load_dwordx4 v13, s[16:19], s39 offen lds
    s_waitcnt lgkmcnt(8)
    v_mfma_f32_16x16x32_bf16 v[24:27], v[116:119], a[104:107], v[24:27]
    v_mfma_f32_16x16x32_bf16 v[28:31], v[116:119], a[108:111], v[28:31]
    s_waitcnt vmcnt(10) lgkmcnt(0)
    s_barrier
    s_setprio 3
    v_mfma_f32_16x16x32_bf16 v[32:35], v[96:99], a[104:107], v[32:35]
    ds_read_b64_tr_b16 v[112:113], v2 offset:16384
    v_mfma_f32_16x16x32_bf16 v[36:39], v[96:99], a[108:111], v[36:39]
    ds_read_b64_tr_b16 v[114:115], v2 offset:16640
    ds_read_b64_tr_b16 v[116:117], v2 offset:17408
    ds_read_b64_tr_b16 v[118:119], v2 offset:17664
    v_mfma_f32_16x16x32_bf16 v[40:43], v[100:103], a[104:107], v[40:43]
    ds_read_b64_tr_b16 v[96:97], v2 offset:18432
    v_mfma_f32_16x16x32_bf16 v[44:47], v[100:103], a[108:111], v[44:47]
    ds_read_b64_tr_b16 v[98:99], v2 offset:18688
    s_add_u32 m0, s51, 98816
    s_add_u32 s39, s36, 49152
    buffer_load_dwordx4 v8, s[16:19], s39 offen lds
    v_mfma_f32_16x16x32_bf16 v[48:51], v[104:107], a[104:107], v[48:51]
    ds_read_b64_tr_b16 v[100:101], v2 offset:19456
    v_mfma_f32_16x16x32_bf16 v[52:55], v[104:107], a[108:111], v[52:55]
    ds_read_b64_tr_b16 v[102:103], v2 offset:19712
    v_mfma_f32_16x16x32_bf16 v[56:59], v[108:111], a[104:107], v[56:59]
    ds_read_b64_tr_b16 v[104:105], v2 offset:20480
    v_mfma_f32_16x16x32_bf16 v[60:63], v[108:111], a[108:111], v[60:63]
    ds_read_b64_tr_b16 v[106:107], v2 offset:20736
    s_waitcnt lgkmcnt(8)
    v_mfma_f32_16x16x32_bf16 v[16:19], v[112:115], a[112:115], v[16:19]
    ds_read_b64_tr_b16 v[108:109], v2 offset:21504
    v_mfma_f32_16x16x32_bf16 v[20:23], v[112:115], a[116:119], v[20:23]
    ds_read_b64_tr_b16 v[110:111], v2 offset:21760
    s_add_u32 m0, s51, 99840
    s_nop 0
    buffer_load_dwordx4 v13, s[16:19], s39 offen lds
    s_waitcnt lgkmcnt(8)
    v_mfma_f32_16x16x32_bf16 v[24:27], v[116:119], a[112:115], v[24:27]
    ds_read_b64_tr_b16 v[112:113], v2 offset:28672
    v_mfma_f32_16x16x32_bf16 v[28:31], v[116:119], a[116:119], v[28:31]
    ds_read_b64_tr_b16 v[114:115], v2 offset:28928
    s_waitcnt lgkmcnt(8)
    v_mfma_f32_16x16x32_bf16 v[32:35], v[96:99], a[112:115], v[32:35]
    ds_read_b64_tr_b16 v[116:117], v2 offset:29696
    v_mfma_f32_16x16x32_bf16 v[36:39], v[96:99], a[116:119], v[36:39]
    ds_read_b64_tr_b16 v[118:119], v2 offset:29952
    s_waitcnt lgkmcnt(8)
    v_mfma_f32_16x16x32_bf16 v[40:43], v[100:103], a[112:115], v[40:43]
    ds_read_b64_tr_b16 v[96:97], v2 offset:30720
    v_mfma_f32_16x16x32_bf16 v[44:47], v[100:103], a[116:119], v[44:47]
    ds_read_b64_tr_b16 v[98:99], v2 offset:30976
    s_add_u32 m0, s51, 115200
    s_add_u32 s39, s36, 65536
    buffer_load_dwordx4 v8, s[16:19], s39 offen lds
    s_waitcnt lgkmcnt(8)
    v_mfma_f32_16x16x32_bf16 v[48:51], v[104:107], a[112:115], v[48:51]
    ds_read_b64_tr_b16 v[100:101], v2 offset:31744
    v_mfma_f32_16x16x32_bf16 v[52:55], v[104:107], a[116:119], v[52:55]
    ds_read_b64_tr_b16 v[102:103], v2 offset:32000
    s_waitcnt lgkmcnt(8)
    v_mfma_f32_16x16x32_bf16 v[56:59], v[108:111], a[112:115], v[56:59]
    ds_read_b64_tr_b16 v[104:105], v2 offset:32768
    v_mfma_f32_16x16x32_bf16 v[60:63], v[108:111], a[116:119], v[60:63]
    ds_read_b64_tr_b16 v[106:107], v2 offset:33024
    s_waitcnt lgkmcnt(8)
    v_mfma_f32_16x16x32_bf16 v[16:19], v[112:115], a[120:123], v[16:19]
    ds_read_b64_tr_b16 v[108:109], v2 offset:33792
    v_mfma_f32_16x16x32_bf16 v[20:23], v[112:115], a[124:127], v[20:23]
    ds_read_b64_tr_b16 v[110:111], v2 offset:34048
    s_add_u32 m0, s51, 116224
    s_nop 0
    buffer_load_dwordx4 v13, s[16:19], s39 offen lds
    s_waitcnt lgkmcnt(8)
    v_mfma_f32_16x16x32_bf16 v[24:27], v[116:119], a[120:123], v[24:27]
    v_mfma_f32_16x16x32_bf16 v[28:31], v[116:119], a[124:127], v[28:31]
    s_waitcnt vmcnt(8) lgkmcnt(0)
    s_barrier
    v_mfma_f32_16x16x32_bf16 v[32:35], v[96:99], a[120:123], v[32:35]
    v_mfma_f32_16x16x32_bf16 v[36:39], v[96:99], a[124:127], v[36:39]
    v_mfma_f32_16x16x32_bf16 v[40:43], v[100:103], a[120:123], v[40:43]
    v_mfma_f32_16x16x32_bf16 v[44:47], v[100:103], a[124:127], v[44:47]
    s_add_u32 m0, s51, 131584
    s_add_u32 s39, s36, 81920
    buffer_load_dwordx4 v8, s[16:19], s39 offen lds
    v_mfma_f32_16x16x32_bf16 v[48:51], v[104:107], a[120:123], v[48:51]
    v_mfma_f32_16x16x32_bf16 v[52:55], v[104:107], a[124:127], v[52:55]
    v_mfma_f32_16x16x32_bf16 v[56:59], v[108:111], a[120:123], v[56:59]
    v_mfma_f32_16x16x32_bf16 v[60:63], v[108:111], a[124:127], v[60:63]
    s_add_u32 m0, s51, 132608
    s_nop 0
    buffer_load_dwordx4 v13, s[16:19], s39 offen lds
    v_xor_b32 v2, 64, v4
    ds_read_b64_tr_b16 a[28:29], v4 offset:49664
    ds_read_b64_tr_b16 a[30:31], v4 offset:50688
    ds_read_b64_tr_b16 a[32:33], v2 offset:49664
    ds_read_b64_tr_b16 a[34:35], v2 offset:50688
    s_waitcnt vmcnt(8)
    v_add_u32 v4, 0x10200, v4
    ds_read_b64_tr_b16 a[36:37], v4 offset:0
    ds_read_b64_tr_b16 a[38:39], v4 offset:1024
    v_add_u32 v2, 0x10200, v2
    ds_read_b64_tr_b16 a[40:41], v2 offset:0
    ds_read_b64_tr_b16 a[42:43], v2 offset:1024
    s_waitcnt lgkmcnt(4)
    s_add_u32 m0, s51, 49664
    s_add_u32 s39, s36, 98304
    buffer_load_dwordx4 v8, s[16:19], s39 offen lds
    s_add_u32 m0, s51, 50688
    s_nop 0
    buffer_load_dwordx4 v13, s[16:19], s39 offen lds
    s_waitcnt lgkmcnt(0)
    s_add_u32 m0, s51, 66048
    s_add_u32 s39, s36, 114688
    buffer_load_dwordx4 v8, s[16:19], s39 offen lds
    s_add_u32 m0, s51, 67072
    s_nop 0
    buffer_load_dwordx4 v13, s[16:19], s39 offen lds
    v_pk_mul_f32 v[16:17], v[16:17], s[4:5]
    v_pk_mul_f32 v[18:19], v[18:19], s[4:5]
    v_pk_mul_f32 v[20:21], v[20:21], s[4:5]
    v_pk_mul_f32 v[22:23], v[22:23], s[4:5]
    v_exp_f32 v16, v16
    v_exp_f32 v17, v17
    v_exp_f32 v18, v18
    v_exp_f32 v19, v19
    v_exp_f32 v20, v20
    v_exp_f32 v21, v21
    v_exp_f32 v22, v22
    v_exp_f32 v23, v23
    v_pk_fma_f32 v[16:17], v[16:17], v[68:69], v[68:69] op_sel_hi:[1,0,0]
    v_pk_fma_f32 v[18:19], v[18:19], v[68:69], v[68:69] op_sel_hi:[1,0,0]
    v_pk_fma_f32 v[20:21], v[20:21], v[68:69], v[68:69] op_sel:[0,1,1] op_sel_hi:[1,1,1]
    v_pk_fma_f32 v[22:23], v[22:23], v[68:69], v[68:69] op_sel:[0,1,1] op_sel_hi:[1,1,1]
    v_rcp_f32 v16, v16
    v_rcp_f32 v17, v17
    v_rcp_f32 v18, v18
    v_rcp_f32 v19, v19
    v_rcp_f32 v20, v20
    v_rcp_f32 v21, v21
    v_rcp_f32 v22, v22
    v_rcp_f32 v23, v23
    v_pk_mul_f32 v[16:17], v[16:17], v[24:25]
    v_pk_mul_f32 v[18:19], v[18:19], v[26:27]
    v_pk_mul_f32 v[20:21], v[20:21], v[28:29]
    v_pk_mul_f32 v[22:23], v[22:23], v[30:31]
    v_cvt_pk_bf16_f32 v96, v16, v17
    v_cvt_pk_bf16_f32 v98, v20, v21
    v_cvt_pk_bf16_f32 v97, v18, v19
    v_cvt_pk_bf16_f32 v99, v22, v23
    v_permlane16_swap_b32 v96, v98
    s_nop 0
    v_permlane16_swap_b32 v97, v99
    buffer_store_dwordx4 v[96:99], v15, s[24:27], s57 offen offset:0 sc1
    v_pk_mul_f32 v[32:33], v[32:33], s[4:5]
    v_pk_mul_f32 v[34:35], v[34:35], s[4:5]
    v_pk_mul_f32 v[36:37], v[36:37], s[4:5]
    v_pk_mul_f32 v[38:39], v[38:39], s[4:5]
    v_exp_f32 v32, v32
    v_exp_f32 v33, v33
    v_exp_f32 v34, v34
    v_exp_f32 v35, v35
    v_exp_f32 v36, v36
    v_exp_f32 v37, v37
    v_exp_f32 v38, v38
    v_exp_f32 v39, v39
    v_pk_fma_f32 v[32:33], v[32:33], v[68:69], v[68:69] op_sel_hi:[1,0,0]
    v_pk_fma_f32 v[34:35], v[34:35], v[68:69], v[68:69] op_sel_hi:[1,0,0]
    v_pk_fma_f32 v[36:37], v[36:37], v[68:69], v[68:69] op_sel:[0,1,1] op_sel_hi:[1,1,1]
    v_pk_fma_f32 v[38:39], v[38:39], v[68:69], v[68:69] op_sel:[0,1,1] op_sel_hi:[1,1,1]
    v_rcp_f32 v32, v32
    v_rcp_f32 v33, v33
    v_rcp_f32 v34, v34
    v_rcp_f32 v35, v35
    v_rcp_f32 v36, v36
    v_rcp_f32 v37, v37
    v_rcp_f32 v38, v38
    v_rcp_f32 v39, v39
    v_pk_mul_f32 v[32:33], v[32:33], v[40:41]
    v_pk_mul_f32 v[34:35], v[34:35], v[42:43]
    v_pk_mul_f32 v[36:37], v[36:37], v[44:45]
    v_pk_mul_f32 v[38:39], v[38:39], v[46:47]
    v_cvt_pk_bf16_f32 v100, v32, v33
    v_cvt_pk_bf16_f32 v102, v36, v37
    v_cvt_pk_bf16_f32 v101, v34, v35
    v_cvt_pk_bf16_f32 v103, v38, v39
    v_permlane16_swap_b32 v100, v102
    s_nop 0
    v_permlane16_swap_b32 v101, v103
    buffer_store_dwordx4 v[100:103], v15, s[24:27], s57 offen offset:2048 sc1
    v_pk_mul_f32 v[48:49], v[48:49], s[4:5]
    v_pk_mul_f32 v[50:51], v[50:51], s[4:5]
    v_pk_mul_f32 v[52:53], v[52:53], s[4:5]
    v_pk_mul_f32 v[54:55], v[54:55], s[4:5]
    v_exp_f32 v48, v48
    v_exp_f32 v49, v49
    v_exp_f32 v50, v50
    v_exp_f32 v51, v51
    v_exp_f32 v52, v52
    v_exp_f32 v53, v53
    v_exp_f32 v54, v54
    v_exp_f32 v55, v55
    v_pk_fma_f32 v[48:49], v[48:49], v[68:69], v[68:69] op_sel_hi:[1,0,0]
    v_pk_fma_f32 v[50:51], v[50:51], v[68:69], v[68:69] op_sel_hi:[1,0,0]
    v_pk_fma_f32 v[52:53], v[52:53], v[68:69], v[68:69] op_sel:[0,1,1] op_sel_hi:[1,1,1]
    v_pk_fma_f32 v[54:55], v[54:55], v[68:69], v[68:69] op_sel:[0,1,1] op_sel_hi:[1,1,1]
    v_rcp_f32 v48, v48
    v_rcp_f32 v49, v49
    v_rcp_f32 v50, v50
    v_rcp_f32 v51, v51
    v_rcp_f32 v52, v52
    v_rcp_f32 v53, v53
    v_rcp_f32 v54, v54
    v_rcp_f32 v55, v55
    v_pk_mul_f32 v[48:49], v[48:49], v[56:57]
    v_pk_mul_f32 v[50:51], v[50:51], v[58:59]
    v_pk_mul_f32 v[52:53], v[52:53], v[60:61]
    v_pk_mul_f32 v[54:55], v[54:55], v[62:63]
    v_cvt_pk_bf16_f32 v104, v48, v49
    v_cvt_pk_bf16_f32 v106, v52, v53
    v_cvt_pk_bf16_f32 v105, v50, v51
    v_cvt_pk_bf16_f32 v107, v54, v55
    v_permlane16_swap_b32 v104, v106
    s_nop 0
    v_permlane16_swap_b32 v105, v107
    buffer_store_dwordx4 v[104:107], v14, s[24:27], s57 offen sc1
    v_mov_b32 v126, 0x7e800000
    ds_read_b128 a[0:3], v12 offset:16384
    ds_read_b128 a[4:7], v12 offset:0
    ds_read_b128 a[8:11], v12 offset:14336
    s_setprio 2
    s_waitcnt lgkmcnt(2)
    v_mfma_f32_32x32x16_bf16 v[16:31], a[0:3], v[120:123], 0
    ds_read_b128 a[0:3], v12 offset:12288
    s_waitcnt lgkmcnt(2)
    v_mfma_f32_32x32x16_bf16 v[32:47], a[4:7], v[120:123], 0
    ds_read_b128 a[4:7], v12 offset:10240
    ds_read_b128 a[12:15], v5 offset:16640
    ds_read_b128 a[16:19], v5 offset:17680
    ds_read_b128 a[20:23], v5 offset:0
    ds_read_b128 a[24:27], v5 offset:1040
    s_nop 6
    v_cndmask_b32_e64 v16, v16, v32, s[64:65]
    v_cndmask_b32_e64 v17, v17, v33, s[66:67]
    v_cndmask_b32_e64 v18, v18, v34, s[68:69]
    v_cndmask_b32_e64 v19, v19, v35, s[70:71]
    v_cndmask_b32_e64 v20, v20, v36, s[72:73]
    v_cndmask_b32_e64 v21, v21, v37, s[74:75]
    v_cndmask_b32_e64 v22, v22, v38, s[76:77]
    v_cndmask_b32_e64 v23, v23, v39, s[78:79]
    v_cndmask_b32_e64 v24, v24, v40, s[80:81]
    v_cndmask_b32_e64 v25, v25, v41, s[82:83]
    v_cndmask_b32_e64 v26, v26, v42, s[84:85]
    v_cndmask_b32_e64 v27, v27, v43, s[86:87]
    v_cndmask_b32_e64 v28, v28, v44, s[88:89]
    v_cndmask_b32_e64 v29, v29, v45, s[90:91]
    v_cndmask_b32_e64 v30, v30, v46, s[92:93]
    v_cndmask_b32_e64 v31, v31, v47, s[94:95]
    s_waitcnt lgkmcnt(6)
    v_mfma_f32_32x32x16_bf16 v[32:47], a[8:11], v[120:123], 0
    ds_read_b128 a[8:11], v12 offset:8192
    v_exp_f32 v16, v16
    v_exp_f32 v17, v17
    v_exp_f32 v18, v18
    v_exp_f32 v19, v19
    v_exp_f32 v20, v20
    v_exp_f32 v21, v21
    v_exp_f32 v22, v22
    v_exp_f32 v23, v23
    v_exp_f32 v24, v24
    v_exp_f32 v25, v25
    v_exp_f32 v26, v26
    v_exp_f32 v27, v27
    v_exp_f32 v28, v28
    v_exp_f32 v29, v29
    v_exp_f32 v30, v30
    v_exp_f32 v31, v31
    v_cvt_pk_bf16_f32 v96, v16, v17
    v_cvt_pk_bf16_f32 v97, v18, v19
    v_cvt_pk_bf16_f32 v98, v20, v21
    v_cvt_pk_bf16_f32 v99, v22, v23
    v_cvt_pk_bf16_f32 v100, v24, v25
    v_cvt_pk_bf16_f32 v101, v26, v27
    v_cvt_pk_bf16_f32 v102, v28, v29
    v_cvt_pk_bf16_f32 v103, v30, v31
    s_waitcnt lgkmcnt(6)
    v_mfma_f32_32x32x16_bf16 v[16:31], a[0:3], v[120:123], 0
    ds_read_b128 a[0:3], v12 offset:6144
    v_and_b32 v104, v96, v88
    v_and_b32 v105, v97, v89
    v_and_b32 v106, v98, v90
    v_and_b32 v107, v99, v91
    v_and_b32 v108, v100, v92
    v_and_b32 v109, v101, v93
    v_and_b32 v110, v102, v94
    v_and_b32 v111, v103, v95
    v_xor_b32 v96, v96, v104
    v_xor_b32 v97, v97, v105
    v_xor_b32 v98, v98, v106
    v_xor_b32 v99, v99, v107
    v_xor_b32 v100, v100, v108
    v_xor_b32 v101, v101, v109
    v_xor_b32 v102, v102, v110
    v_xor_b32 v103, v103, v111
    s_waitcnt lgkmcnt(3)
    v_mfma_f32_32x32x16_bf16 v[64:79], a[20:23], v[104:107], 0
    s_waitcnt lgkmcnt(2)
    v_mfma_f32_32x32x16_bf16 v[64:79], a[24:27], v[108:111], v[64:79]
    v_mfma_f32_32x32x16_bf16 v[64:79], a[12:15], v[96:99], v[64:79]
    v_mfma_f32_32x32x16_bf16 v[64:79], a[16:19], v[100:103], v[64:79]
    ds_read_b128 a[20:23], v5 offset:14560
    ds_read_b128 a[24:27], v5 offset:15600
    ds_read_b128 a[12:15], v5 offset:12480
    ds_read_b128 a[16:19], v5 offset:13520
    v_exp_f32 v32, v32
    v_exp_f32 v33, v33
    v_exp_f32 v34, v34
    v_exp_f32 v35, v35
    v_exp_f32 v36, v36
    v_exp_f32 v37, v37
    v_exp_f32 v38, v38
    v_exp_f32 v39, v39
    v_exp_f32 v40, v40
    v_exp_f32 v41, v41
    v_exp_f32 v42, v42
    v_exp_f32 v43, v43
    v_exp_f32 v44, v44
    v_exp_f32 v45, v45
    v_exp_f32 v46, v46
    v_exp_f32 v47, v47
    v_cvt_pk_bf16_f32 v104, v32, v33
    v_cvt_pk_bf16_f32 v105, v34, v35
    v_cvt_pk_bf16_f32 v106, v36, v37
    v_cvt_pk_bf16_f32 v107, v38, v39
    v_cvt_pk_bf16_f32 v108, v40, v41
    v_cvt_pk_bf16_f32 v109, v42, v43
    v_cvt_pk_bf16_f32 v110, v44, v45
    v_cvt_pk_bf16_f32 v111, v46, v47
    v_mfma_f32_32x32x16_bf16 v[32:47], a[4:7], v[120:123], 0
    ds_read_b128 a[4:7], v12 offset:4096
    s_waitcnt lgkmcnt(4)
    v_mfma_f32_32x32x16_bf16 v[64:79], a[20:23], v[104:107], v[64:79]
    s_waitcnt lgkmcnt(3)
    v_mfma_f32_32x32x16_bf16 v[64:79], a[24:27], v[108:111], v[64:79]
    ds_read_b128 a[20:23], v5 offset:10400
    ds_read_b128 a[24:27], v5 offset:11440
    v_exp_f32 v16, v16
    v_exp_f32 v17, v17
    v_exp_f32 v18, v18
    v_exp_f32 v19, v19
    v_exp_f32 v20, v20
    v_exp_f32 v21, v21
    v_exp_f32 v22, v22
    v_exp_f32 v23, v23
    v_exp_f32 v24, v24
    v_exp_f32 v25, v25
    v_exp_f32 v26, v26
    v_exp_f32 v27, v27
    v_exp_f32 v28, v28
    v_exp_f32 v29, v29
    v_exp_f32 v30, v30
    v_exp_f32 v31, v31
    v_cvt_pk_bf16_f32 v96, v16, v17
    v_cvt_pk_bf16_f32 v97, v18, v19
    v_cvt_pk_bf16_f32 v98, v20, v21
    v_cvt_pk_bf16_f32 v99, v22, v23
    v_cvt_pk_bf16_f32 v100, v24, v25
    v_cvt_pk_bf16_f32 v101, v26, v27
    v_cvt_pk_bf16_f32 v102, v28, v29
    v_cvt_pk_bf16_f32 v103, v30, v31
    v_mfma_f32_32x32x16_bf16 v[16:31], a[8:11], v[120:123], 0
    ds_read_b128 a[8:11], v12 offset:2048
    s_waitcnt lgkmcnt(5)
    v_mfma_f32_32x32x16_bf16 v[64:79], a[12:15], v[96:99], v[64:79]
    s_waitcnt lgkmcnt(4)
    v_mfma_f32_32x32x16_bf16 v[64:79], a[16:19], v[100:103], v[64:79]
    s_waitcnt vmcnt(0)
    s_mov_b64 exec, 1
    buffer_store_dword v127, off, s[24:27], s1 sc1
    s_mov_b64 exec, -1
    ds_read_b128 a[12:15], v5 offset:8320
    ds_read_b128 a[16:19], v5 offset:9360
    v_exp_f32 v32, v32
    v_exp_f32 v33, v33
    v_exp_f32 v34, v34
    v_exp_f32 v35, v35
    v_exp_f32 v36, v36
    v_exp_f32 v37, v37
    v_exp_f32 v38, v38
    v_exp_f32 v39, v39
    v_exp_f32 v40, v40
    v_exp_f32 v41, v41
    v_exp_f32 v42, v42
    v_exp_f32 v43, v43
    v_exp_f32 v44, v44
    v_exp_f32 v45, v45
    v_exp_f32 v46, v46
    v_exp_f32 v47, v47
    v_cvt_pk_bf16_f32 v104, v32, v33
    v_cvt_pk_bf16_f32 v105, v34, v35
    v_cvt_pk_bf16_f32 v106, v36, v37
    v_cvt_pk_bf16_f32 v107, v38, v39
    v_cvt_pk_bf16_f32 v108, v40, v41
    v_cvt_pk_bf16_f32 v109, v42, v43
    v_cvt_pk_bf16_f32 v110, v44, v45
    v_cvt_pk_bf16_f32 v111, v46, v47
    v_mfma_f32_32x32x16_bf16 v[32:47], a[0:3], v[120:123], 0
    s_waitcnt lgkmcnt(4)
    v_mfma_f32_32x32x16_bf16 v[64:79], a[20:23], v[104:107], v[64:79]
    s_waitcnt lgkmcnt(3)
    v_mfma_f32_32x32x16_bf16 v[64:79], a[24:27], v[108:111], v[64:79]
    ds_read_b128 a[20:23], v5 offset:6240
    ds_read_b128 a[24:27], v5 offset:7280
    v_exp_f32 v16, v16
    v_exp_f32 v17, v17
    v_exp_f32 v18, v18
    v_exp_f32 v19, v19
    v_exp_f32 v20, v20
    v_exp_f32 v21, v21
    v_exp_f32 v22, v22
    v_exp_f32 v23, v23
    v_exp_f32 v24, v24
    v_exp_f32 v25, v25
    v_exp_f32 v26, v26
    v_exp_f32 v27, v27
    v_exp_f32 v28, v28
    v_exp_f32 v29, v29
    v_exp_f32 v30, v30
    v_exp_f32 v31, v31
    v_cvt_pk_bf16_f32 v96, v16, v17
    v_cvt_pk_bf16_f32 v97, v18, v19
    v_cvt_pk_bf16_f32 v98, v20, v21
    v_cvt_pk_bf16_f32 v99, v22, v23
    v_cvt_pk_bf16_f32 v100, v24, v25
    v_cvt_pk_bf16_f32 v101, v26, v27
    v_cvt_pk_bf16_f32 v102, v28, v29
    v_cvt_pk_bf16_f32 v103, v30, v31
    v_mfma_f32_32x32x16_bf16 v[16:31], a[4:7], v[120:123], 0
    s_waitcnt lgkmcnt(3)
    v_mfma_f32_32x32x16_bf16 v[64:79], a[12:15], v[96:99], v[64:79]
    s_waitcnt lgkmcnt(2)
    v_mfma_f32_32x32x16_bf16 v[64:79], a[16:19], v[100:103], v[64:79]
    ds_read_b128 a[12:15], v5 offset:4160
    ds_read_b128 a[16:19], v5 offset:5200
    v_exp_f32 v32, v32
    v_exp_f32 v33, v33
    v_exp_f32 v34, v34
    v_exp_f32 v35, v35
    v_exp_f32 v36, v36
    v_exp_f32 v37, v37
    v_exp_f32 v38, v38
    v_exp_f32 v39, v39
    v_exp_f32 v40, v40
    v_exp_f32 v41, v41
    v_exp_f32 v42, v42
    v_exp_f32 v43, v43
    v_exp_f32 v44, v44
    v_exp_f32 v45, v45
    v_exp_f32 v46, v46
    v_exp_f32 v47, v47
    v_cvt_pk_bf16_f32 v104, v32, v33
    v_cvt_pk_bf16_f32 v105, v34, v35
    v_cvt_pk_bf16_f32 v106, v36, v37
    v_cvt_pk_bf16_f32 v107, v38, v39
    v_cvt_pk_bf16_f32 v108, v40, v41
    v_cvt_pk_bf16_f32 v109, v42, v43
    v_cvt_pk_bf16_f32 v110, v44, v45
    v_cvt_pk_bf16_f32 v111, v46, v47
    v_mfma_f32_32x32x16_bf16 v[32:47], a[8:11], v[120:123], 0
    s_waitcnt lgkmcnt(3)
    v_mfma_f32_32x32x16_bf16 v[64:79], a[20:23], v[104:107], v[64:79]
    s_waitcnt lgkmcnt(2)
    v_mfma_f32_32x32x16_bf16 v[64:79], a[24:27], v[108:111], v[64:79]
    ds_read_b128 a[20:23], v5 offset:2080
    ds_read_b128 a[24:27], v5 offset:3120
    v_exp_f32 v16, v16
    v_exp_f32 v17, v17
    v_exp_f32 v18, v18
    v_exp_f32 v19, v19
    v_exp_f32 v20, v20
    v_exp_f32 v21, v21
    v_exp_f32 v22, v22
    v_exp_f32 v23, v23
    v_exp_f32 v24, v24
    v_exp_f32 v25, v25
    v_exp_f32 v26, v26
    v_exp_f32 v27, v27
    v_exp_f32 v28, v28
    v_exp_f32 v29, v29
    v_exp_f32 v30, v30
    v_exp_f32 v31, v31
    v_cvt_pk_bf16_f32 v96, v16, v17
    v_cvt_pk_bf16_f32 v97, v18, v19
    v_cvt_pk_bf16_f32 v98, v20, v21
    v_cvt_pk_bf16_f32 v99, v22, v23
    v_cvt_pk_bf16_f32 v100, v24, v25
    v_cvt_pk_bf16_f32 v101, v26, v27
    v_cvt_pk_bf16_f32 v102, v28, v29
    v_cvt_pk_bf16_f32 v103, v30, v31
    s_waitcnt lgkmcnt(3)
    v_mfma_f32_32x32x16_bf16 v[64:79], a[12:15], v[96:99], v[64:79]
    s_waitcnt lgkmcnt(2)
    v_mfma_f32_32x32x16_bf16 v[64:79], a[16:19], v[100:103], v[64:79]
    v_exp_f32 v32, v32
    v_exp_f32 v33, v33
    v_exp_f32 v34, v34
    v_exp_f32 v35, v35
    v_exp_f32 v36, v36
    v_exp_f32 v37, v37
    v_exp_f32 v38, v38
    v_exp_f32 v39, v39
    v_exp_f32 v40, v40
    v_exp_f32 v41, v41
    v_exp_f32 v42, v42
    v_exp_f32 v43, v43
    v_exp_f32 v44, v44
    v_exp_f32 v45, v45
    v_exp_f32 v46, v46
    v_exp_f32 v47, v47
    v_cvt_pk_bf16_f32 v104, v32, v33
    v_cvt_pk_bf16_f32 v105, v34, v35
    v_cvt_pk_bf16_f32 v106, v36, v37
    v_cvt_pk_bf16_f32 v107, v38, v39
    v_cvt_pk_bf16_f32 v108, v40, v41
    v_cvt_pk_bf16_f32 v109, v42, v43
    v_cvt_pk_bf16_f32 v110, v44, v45
    v_cvt_pk_bf16_f32 v111, v46, v47
    s_waitcnt lgkmcnt(1)
    v_mfma_f32_32x32x16_bf16 v[64:79], a[20:23], v[104:107], v[64:79]
    s_waitcnt lgkmcnt(0)
    v_mfma_f32_32x32x16_bf16 v[64:79], a[24:27], v[108:111], v[64:79]
    v_mov_b32 v80, 0x35800000
    v_mov_b32 v81, 0x4b800000
    s_nop 9
    v_add_f32_e64 v82, |v64|, |v65|
    v_add_f32_e64 v83, |v66|, |v67|
    v_add_f32_e64 v84, |v68|, |v69|
    v_add_f32_e64 v85, |v70|, |v71|
    v_med3_f32 v80, v72, v80, v81
    v_pk_add_f32 v[82:83], v[82:83], v[84:85]
    v_cmp_neq_f32_e64 s[4:5], v80, v72
    v_add_f32 v82, v82, v83
    v_cmp_nlt_f32 vcc, v82, v126
    s_nop 0
    s_or_b64 vcc, vcc, s[4:5]
    s_cbranch_scc1 L_slow_1005
L_back_1006:
    buffer_load_dword v124, v10, s[24:27], s58 offen sc1
    v_rcp_f32 v72, v72
    v_add_u32 v14, 120832, v15
    v_mul_f32 v72, v72, v3
    v_pk_mul_f32 v[64:65], v[64:65], v[72:73] op_sel_hi:[1,0]
    v_pk_mul_f32 v[66:67], v[66:67], v[72:73] op_sel_hi:[1,0]
    v_pk_mul_f32 v[68:69], v[68:69], v[72:73] op_sel_hi:[1,0]
    v_pk_mul_f32 v[70:71], v[70:71], v[72:73] op_sel_hi:[1,0]
    v_cvt_pk_bf16_f32 v120, v64, v65
    v_cvt_pk_bf16_f32 v121, v66, v67
    v_cvt_pk_bf16_f32 v122, v68, v69
    v_cvt_pk_bf16_f32 v123, v70, v71
    s_setprio 0
    ds_read_b64_tr_b16 a[44:45], v4 offset:16384
    ds_read_b64_tr_b16 a[46:47], v4 offset:17408
    ds_read_b64_tr_b16 a[48:49], v2 offset:16384
    ds_read_b64_tr_b16 a[50:51], v2 offset:17408
    ds_read_b64_tr_b16 a[52:53], v4 offset:32768
    ds_read_b64_tr_b16 a[54:55], v4 offset:33792
    ds_read_b64_tr_b16 a[56:57], v2 offset:32768
    ds_read_b64_tr_b16 a[58:59], v2 offset:33792
    ds_read_b64_tr_b16 a[60:61], v4 offset:49152
    ds_read_b64_tr_b16 a[62:63], v4 offset:50176
    ds_read_b64_tr_b16 a[64:65], v2 offset:49152
    ds_read_b64_tr_b16 a[66:67], v2 offset:50176
    v_add_u32 v4, 0x10000, v4
    ds_read_b64_tr_b16 a[68:69], v4 offset:0
    ds_read_b64_tr_b16 a[70:71], v4 offset:1024
    v_add_u32 v2, 0x10000, v2
    ds_read_b64_tr_b16 a[72:73], v2 offset:0
    ds_read_b64_tr_b16 a[74:75], v2 offset:1024
    v_add_u32 v4, 0xfffec000, v4
    ds_read_b64_tr_b16 a[76:77], v4 offset:0
    ds_read_b64_tr_b16 a[78:79], v4 offset:1024
    v_add_u32 v2, 0xfffec000, v2
    ds_read_b64_tr_b16 a[80:81], v2 offset:0
    ds_read_b64_tr_b16 a[82:83], v2 offset:1024
    ds_read_b64_tr_b16 a[84:85], v4 offset:16384
    ds_read_b64_tr_b16 a[86:87], v4 offset:17408
    ds_read_b64_tr_b16 a[88:89], v2 offset:16384
    ds_read_b64_tr_b16 a[90:91], v2 offset:17408
    s_waitcnt lgkmcnt(15)
    s_add_u32 m0, s51, 82432
    s_add_u32 s39, s36, 131072
    buffer_load_dwordx4 v8, s[16:19], s39 offen lds
    s_add_u32 m0, s51, 83456
    s_nop 0
    buffer_load_dwordx4 v13, s[16:19], s39 offen lds
    s_add_u32 m0, s51, 98816
    s_add_u32 s39, s36, 147456
    buffer_load_dwordx4 v8, s[16:19], s39 offen lds
    s_add_u32 m0, s51, 99840
    s_nop 0
    buffer_load_dwordx4 v13, s[16:19], s39 offen lds
    s_waitcnt vmcnt(4)
    v_cmp_ne_u32 vcc, v127, v124
    s_cbranch_vccz L_ok_1007
    s_mov_b32 s63, 0x40000
L_spin_1008:
    s_sub_u32 s63, s63, 1
    s_cbranch_scc1 L_ok_1007
    s_sleep 1
    buffer_load_dword v124, v10, s[24:27], s58 offen sc1
    s_waitcnt vmcnt(0)
    v_cmp_ne_u32 vcc, v127, v124
    s_cbranch_vccnz L_spin_1008
L_ok_1007:
    buffer_store_dwordx4 v[120:123], v15, s[24:27], s41 offen sc1
    buffer_load_dwordx4 v[80:83], v15, s[24:27], s37 offen offset:0 sc1
    buffer_load_dwordx4 v[84:87], v14, s[24:27], s37 offen offset:0 sc1
    buffer_load_dwordx4 v[88:91], v15, s[24:27], s37 offen offset:1024 sc1
    buffer_load_dwordx4 v[92:95], v14, s[24:27], s37 offen offset:1024 sc1
    buffer_load_dwordx4 v[96:99], v15, s[24:27], s37 offen offset:2048 sc1
    buffer_load_dwordx4 v[100:103], v14, s[24:27], s37 offen offset:2048 sc1
    buffer_load_dwordx4 v[104:107], v15, s[24:27], s37 offen offset:3072 sc1
    buffer_load_dwordx4 v[108:111], v14, s[24:27], s37 offen offset:3072 sc1
    s_add_u32 s37, s37, 0x1000
    buffer_load_dwordx4 v[112:115], v15, s[24:27], s37 offen offset:0 sc1
    buffer_load_dwordx4 v[116:119], v14, s[24:27], s37 offen offset:0 sc1
    s_waitcnt lgkmcnt(12)
    s_add_u32 m0, s51, 115200
    s_add_u32 s39, s36, 163840
    buffer_load_dwordx4 v8, s[16:19], s39 offen lds
    s_add_u32 m0, s51, 116224
    s_nop 0
    buffer_load_dwordx4 v13, s[16:19], s39 offen lds
    s_waitcnt lgkmcnt(8)
    s_add_u32 m0, s51, 131584
    s_add_u32 s39, s36, 180224
    buffer_load_dwordx4 v8, s[16:19], s39 offen lds
    s_add_u32 m0, s51, 132608
    s_nop 0
    buffer_load_dwordx4 v13, s[16:19], s39 offen lds
    s_waitcnt lgkmcnt(4)
    s_add_u32 m0, s51, 49664
    s_add_u32 s39, s36, 196608
    buffer_load_dwordx4 v8, s[16:19], s39 offen lds
    s_add_u32 m0, s51, 50688
    s_nop 0
    buffer_load_dwordx4 v13, s[16:19], s39 offen lds
    s_waitcnt lgkmcnt(0)
    s_add_u32 m0, s51, 66048
    s_add_u32 s39, s36, 212992
    buffer_load_dwordx4 v8, s[16:19], s39 offen lds
    s_add_u32 m0, s51, 67072
    s_nop 0
    buffer_load_dwordx4 v13, s[16:19], s39 offen lds
    s_waitcnt vmcnt(17)
    v_mfma_f32_32x32x16_bf16 v[16:31], v[80:83], a[28:31], 0
    v_mfma_f32_32x32x16_bf16 v[32:47], v[80:83], a[32:35], 0
    s_waitcnt vmcnt(16)
    v_mfma_f32_32x32x16_bf16 v[48:63], v[84:87], a[28:31], 0
    v_mfma_f32_32x32x16_bf16 v[64:79], v[84:87], a[32:35], 0
    ds_read_b64_tr_b16 a[92:93], v4 offset:32768
    ds_read_b64_tr_b16 a[94:95], v4 offset:33792
    ds_read_b64_tr_b16 a[96:97], v2 offset:32768
    ds_read_b64_tr_b16 a[98:99], v2 offset:33792
    buffer_load_dwordx4 a[28:31], v15, s[24:27], s37 offen offset:1024 sc1
    buffer_load_dwordx4 a[32:35], v14, s[24:27], s37 offen offset:1024 sc1
    s_waitcnt vmcnt(17)
    v_mfma_f32_32x32x16_bf16 v[16:31], v[88:91], a[36:39], v[16:31]
    v_mfma_f32_32x32x16_bf16 v[32:47], v[88:91], a[40:43], v[32:47]
    s_waitcnt vmcnt(16)
    v_mfma_f32_32x32x16_bf16 v[48:63], v[92:95], a[36:39], v[48:63]
    v_mfma_f32_32x32x16_bf16 v[64:79], v[92:95], a[40:43], v[64:79]
    s_add_u32 s3, s1, 262144
    s_mov_b64 exec, 1
    buffer_store_dword v127, off, s[24:27], s3 sc1
    s_mov_b64 exec, -1
    ds_read_b64_tr_b16 a[100:101], v4 offset:49152
    ds_read_b64_tr_b16 a[102:103], v4 offset:50176
    ds_read_b64_tr_b16 a[104:105], v2 offset:49152
    ds_read_b64_tr_b16 a[106:107], v2 offset:50176
    buffer_load_dwordx4 a[36:39], v15, s[24:27], s37 offen offset:2048 sc1
    buffer_load_dwordx4 a[40:43], v14, s[24:27], s37 offen offset:2048 sc1
    s_waitcnt vmcnt(18)
    v_mfma_f32_32x32x16_bf16 v[16:31], v[96:99], a[44:47], v[16:31]
    v_mfma_f32_32x32x16_bf16 v[32:47], v[96:99], a[48:51], v[32:47]
    s_waitcnt vmcnt(17)
    v_mfma_f32_32x32x16_bf16 v[48:63], v[100:103], a[44:47], v[48:63]
    v_mfma_f32_32x32x16_bf16 v[64:79], v[100:103], a[48:51], v[64:79]
    s_waitcnt vmcnt(11)
    v_add_u32 v4, 0x10000, v4
    ds_read_b64_tr_b16 a[108:109], v4 offset:0
    ds_read_b64_tr_b16 a[110:111], v4 offset:1024
    v_add_u32 v2, 0x10000, v2
    ds_read_b64_tr_b16 a[112:113], v2 offset:0
    ds_read_b64_tr_b16 a[114:115], v2 offset:1024
    buffer_load_dwordx4 a[44:47], v15, s[24:27], s37 offen offset:3072 sc1
    buffer_load_dwordx4 a[48:51], v14, s[24:27], s37 offen offset:3072 sc1
    v_mfma_f32_32x32x16_bf16 v[16:31], v[104:107], a[52:55], v[16:31]
    v_mfma_f32_32x32x16_bf16 v[32:47], v[104:107], a[56:59], v[32:47]
    v_mfma_f32_32x32x16_bf16 v[48:63], v[108:111], a[52:55], v[48:63]
    v_mfma_f32_32x32x16_bf16 v[64:79], v[108:111], a[56:59], v[64:79]
    s_waitcnt vmcnt(11)
    ds_read_b64_tr_b16 a[116:117], v4 offset:16384
    ds_read_b64_tr_b16 a[118:119], v4 offset:17408
    ds_read_b64_tr_b16 a[120:121], v2 offset:16384
    ds_read_b64_tr_b16 a[122:123], v2 offset:17408
    s_add_u32 s37, s37, 0x1000
    buffer_load_dwordx4 a[52:55], v15, s[24:27], s37 offen offset:0 sc1
    buffer_load_dwordx4 a[56:59], v14, s[24:27], s37 offen offset:0 sc1
    v_mfma_f32_32x32x16_bf16 v[16:31], v[112:115], a[60:63], v[16:31]
    v_mfma_f32_32x32x16_bf16 v[32:47], v[112:115], a[64:67], v[32:47]
    v_mfma_f32_32x32x16_bf16 v[48:63], v[116:119], a[60:63], v[48:63]
    v_mfma_f32_32x32x16_bf16 v[64:79], v[116:119], a[64:67], v[64:79]
    s_waitcnt vmcnt(11)
    v_add_u32 v4, 0xffff0000, v4
    ds_read_b64_tr_b16 a[0:1], v4 offset:0
    ds_read_b64_tr_b16 a[2:3], v4 offset:1024
    v_add_u32 v2, 0xffff0000, v2
    ds_read_b64_tr_b16 a[4:5], v2 offset:0
    ds_read_b64_tr_b16 a[6:7], v2 offset:1024
    buffer_load_dwordx4 a[60:63], v15, s[24:27], s37 offen offset:1024 sc1
    buffer_load_dwordx4 a[64:67], v14, s[24:27], s37 offen offset:1024 sc1
    s_waitcnt vmcnt(10)
    v_mfma_f32_32x32x16_bf16 v[16:31], a[28:31], a[68:71], v[16:31]
    v_mfma_f32_32x32x16_bf16 v[32:47], a[28:31], a[72:75], v[32:47]
    s_waitcnt vmcnt(9)
    v_mfma_f32_32x32x16_bf16 v[48:63], a[32:35], a[68:71], v[48:63]
    v_mfma_f32_32x32x16_bf16 v[64:79], a[32:35], a[72:75], v[64:79]
    ds_read_b64_tr_b16 a[8:9], v4 offset:16384
    ds_read_b64_tr_b16 a[10:11], v4 offset:17408
    ds_read_b64_tr_b16 a[12:13], v2 offset:16384
    ds_read_b64_tr_b16 a[14:15], v2 offset:17408
    buffer_load_dwordx4 a[68:71], v15, s[24:27], s37 offen offset:2048 sc1
    buffer_load_dwordx4 a[72:75], v14, s[24:27], s37 offen offset:2048 sc1
    s_waitcnt vmcnt(9)
    v_mfma_f32_32x32x16_bf16 v[16:31], a[36:39], a[76:79], v[16:31]
    v_mfma_f32_32x32x16_bf16 v[32:47], a[36:39], a[80:83], v[32:47]
    s_waitcnt vmcnt(8)
    v_mfma_f32_32x32x16_bf16 v[48:63], a[40:43], a[76:79], v[48:63]
    v_mfma_f32_32x32x16_bf16 v[64:79], a[40:43], a[80:83], v[64:79]
    buffer_load_dwordx4 a[76:79], v15, s[24:27], s37 offen offset:3072 sc1
    buffer_load_dwordx4 a[80:83], v14, s[24:27], s37 offen offset:3072 sc1
    s_waitcnt vmcnt(9)
    v_mfma_f32_32x32x16_bf16 v[16:31], a[44:47], a[84:87], v[16:31]
    v_mfma_f32_32x32x16_bf16 v[32:47], a[44:47], a[88:91], v[32:47]
    s_waitcnt vmcnt(8)
    v_mfma_f32_32x32x16_bf16 v[48:63], a[48:51], a[84:87], v[48:63]
    v_mfma_f32_32x32x16_bf16 v[64:79], a[48:51], a[88:91], v[64:79]
    s_add_u32 s37, s37, 0x1000
    buffer_load_dwordx4 a[84:87], v15, s[24:27], s37 offen offset:0 sc1
    buffer_load_dwordx4 a[88:91], v14, s[24:27], s37 offen offset:0 sc1
    s_waitcnt lgkmcnt(15)
    s_waitcnt vmcnt(9)
    v_mfma_f32_32x32x16_bf16 v[16:31], a[52:55], a[92:95], v[16:31]
    v_mfma_f32_32x32x16_bf16 v[32:47], a[52:55], a[96:99], v[32:47]
    s_waitcnt vmcnt(8)
    v_mfma_f32_32x32x16_bf16 v[48:63], a[56:59], a[92:95], v[48:63]
    v_mfma_f32_32x32x16_bf16 v[64:79], a[56:59], a[96:99], v[64:79]
    buffer_load_dwordx4 a[92:95], v15, s[24:27], s37 offen offset:1024 sc1
    buffer_load_dwordx4 a[96:99], v14, s[24:27], s37 offen offset:1024 sc1
    s_waitcnt vmcnt(9)
    v_mfma_f32_32x32x16_bf16 v[16:31], a[60:63], a[100:103], v[16:31]
    v_mfma_f32_32x32x16_bf16 v[32:47], a[60:63], a[104:107], v[32:47]
    s_waitcnt vmcnt(8)
    v_mfma_f32_32x32x16_bf16 v[48:63], a[64:67], a[100:103], v[48:63]
    v_mfma_f32_32x32x16_bf16 v[64:79], a[64:67], a[104:107], v[64:79]
    s_waitcnt lgkmcnt(12)
    s_waitcnt vmcnt(7)
    v_mfma_f32_32x32x16_bf16 v[16:31], a[68:71], a[108:111], v[16:31]
    v_mfma_f32_32x32x16_bf16 v[32:47], a[68:71], a[112:115], v[32:47]
    s_waitcnt vmcnt(6)
    v_mfma_f32_32x32x16_bf16 v[48:63], a[72:75], a[108:111], v[48:63]
    v_mfma_f32_32x32x16_bf16 v[64:79], a[72:75], a[112:115], v[64:79]
    s_waitcnt lgkmcnt(8)
    s_waitcnt vmcnt(5)
    v_mfma_f32_32x32x16_bf16 v[16:31], a[76:79], a[116:119], v[16:31]
    v_mfma_f32_32x32x16_bf16 v[32:47], a[76:79], a[120:123], v[32:47]
    s_waitcnt vmcnt(4)
    v_mfma_f32_32x32x16_bf16 v[48:63], a[80:83], a[116:119], v[48:63]
    v_mfma_f32_32x32x16_bf16 v[64:79], a[80:83], a[120:123], v[64:79]
    s_waitcnt lgkmcnt(4)
    s_waitcnt vmcnt(3)
    v_mfma_f32_32x32x16_bf16 v[16:31], a[84:87], a[0:3], v[16:31]
    v_mfma_f32_32x32x16_bf16 v[32:47], a[84:87], a[4:7], v[32:47]
    s_waitcnt vmcnt(2)
    v_mfma_f32_32x32x16_bf16 v[48:63], a[88:91], a[0:3], v[48:63]
    v_mfma_f32_32x32x16_bf16 v[64:79], a[88:91], a[4:7], v[64:79]
    s_waitcnt lgkmcnt(0)
    s_waitcnt vmcnt(1)
    v_mfma_f32_32x32x16_bf16 v[16:31], a[92:95], a[8:11], v[16:31]
    v_mfma_f32_32x32x16_bf16 v[32:47], a[92:95], a[12:15], v[32:47]
    s_waitcnt vmcnt(0)
    v_mfma_f32_32x32x16_bf16 v[48:63], a[96:99], a[8:11], v[48:63]
    v_mfma_f32_32x32x16_bf16 v[64:79], a[96:99], a[12:15], v[64:79]
    v_xor_b32 v2, 16, v6
    s_mov_b32 s64, 0xf0f0f0f0
    s_mov_b32 s65, 0xf0f0f0f0
    s_add_u32 s54, s59, 0x8000
    s_setprio 3
    s_barrier
    s_lshl_b32 s3, s42, 14
    s_add_u32 m0, s3, 0
    s_nop 0
    ds_write_addtid_b32 v16 offset:0
    ds_write_addtid_b32 v17 offset:256
    ds_write_addtid_b32 v18 offset:512
    ds_write_addtid_b32 v19 offset:768
    ds_write_addtid_b32 v20 offset:1024
    ds_write_addtid_b32 v21 offset:1280
    ds_write_addtid_b32 v22 offset:1536
    ds_write_addtid_b32 v23 offset:1792
    ds_write_addtid_b32 v24 offset:2048
    ds_write_addtid_b32 v25 offset:2304
    ds_write_addtid_b32 v26 offset:2560
    ds_write_addtid_b32 v27 offset:2816
    ds_write_addtid_b32 v28 offset:3072
    ds_write_addtid_b32 v29 offset:3328
    ds_write_addtid_b32 v30 offset:3584
    ds_write_addtid_b32 v31 offset:3840
    ds_write_addtid_b32 v32 offset:4096
    ds_write_addtid_b32 v33 offset:4352
    ds_write_addtid_b32 v34 offset:4608
    ds_write_addtid_b32 v35 offset:4864
    ds_write_addtid_b32 v36 offset:5120
    ds_write_addtid_b32 v37 offset:5376
    ds_write_addtid_b32 v38 offset:5632
    ds_write_addtid_b32 v39 offset:5888
    ds_write_addtid_b32 v40 offset:6144
    ds_write_addtid_b32 v41 offset:6400
    ds_write_addtid_b32 v42 offset:6656
    ds_write_addtid_b32 v43 offset:6912
    ds_write_addtid_b32 v44 offset:7168
    ds_write_addtid_b32 v45 offset:7424
    ds_write_addtid_b32 v46 offset:7680
    ds_write_addtid_b32 v47 offset:7936
    ds_write_addtid_b32 v48 offset:8192
    ds_write_addtid_b32 v49 offset:8448
    ds_write_addtid_b32 v50 offset:8704
    ds_write_addtid_b32 v51 offset:8960
    ds_write_addtid_b32 v52 offset:9216
    ds_write_addtid_b32 v53 offset:9472
    ds_write_addtid_b32 v54 offset:9728
    ds_write_addtid_b32 v55 offset:9984
    ds_write_addtid_b32 v56 offset:10240
    ds_write_addtid_b32 v57 offset:10496
    ds_write_addtid_b32 v58 offset:10752
    ds_write_addtid_b32 v59 offset:11008
    ds_write_addtid_b32 v60 offset:11264
    ds_write_addtid_b32 v61 offset:11520
    ds_write_addtid_b32 v62 offset:11776
    ds_write_addtid_b32 v63 offset:12032
    ds_write_addtid_b32 v64 offset:12288
    ds_write_addtid_b32 v65 offset:12544
    ds_write_addtid_b32 v66 offset:12800
    ds_write_addtid_b32 v67 offset:13056
    ds_write_addtid_b32 v68 offset:13312
    ds_write_addtid_b32 v69 offset:13568
    ds_write_addtid_b32 v70 offset:13824
    ds_write_addtid_b32 v71 offset:14080
    ds_write_addtid_b32 v72 offset:14336
    ds_write_addtid_b32 v73 offset:14592
    ds_write_addtid_b32 v74 offset:14848
    ds_write_addtid_b32 v75 offset:15104
    ds_write_addtid_b32 v76 offset:15360
    ds_write_addtid_b32 v77 offset:15616
    ds_write_addtid_b32 v78 offset:15872
    ds_write_addtid_b32 v79 offset:16128
    s_waitcnt lgkmcnt(0)
    s_barrier
    ds_read_b128 v[16:19], v6 offset:0
    ds_read_b128 v[20:23], v2 offset:0
    ds_read_b128 v[24:27], v6 offset:16384
    ds_read_b128 v[28:31], v2 offset:16384
    ds_read_b128 v[32:35], v6 offset:32768
    ds_read_b128 v[36:39], v2 offset:32768
    ds_read_b128 v[40:43], v6 offset:49152
    ds_read_b128 v[44:47], v2 offset:49152
    ds_read_b128 v[48:51], v6 offset:8192
    ds_read_b128 v[52:55], v2 offset:8192
    ds_read_b128 v[56:59], v6 offset:24576
    ds_read_b128 v[60:63], v2 offset:24576
    ds_read_b128 v[64:67], v6 offset:40960
    ds_read_b128 v[68:71], v2 offset:40960
    ds_read_b128 v[72:75], v6 offset:57344
    ds_read_b128 v[76:79], v2 offset:57344
    s_waitcnt lgkmcnt(12)
    v_pk_add_f32 v[16:17], v[16:17], v[24:25]
    v_pk_add_f32 v[18:19], v[18:19], v[26:27]
    v_pk_add_f32 v[20:21], v[20:21], v[28:29]
    v_pk_add_f32 v[22:23], v[22:23], v[30:31]
    s_waitcnt lgkmcnt(8)
    v_pk_add_f32 v[32:33], v[32:33], v[40:41]
    v_pk_add_f32 v[34:35], v[34:35], v[42:43]
    v_pk_add_f32 v[36:37], v[36:37], v[44:45]
    v_pk_add_f32 v[38:39], v[38:39], v[46:47]
    v_pk_add_f32 v[96:97], v[16:17], v[32:33]
    v_pk_add_f32 v[98:99], v[18:19], v[34:35]
    v_pk_add_f32 v[100:101], v[20:21], v[36:37]
    v_pk_add_f32 v[102:103], v[22:23], v[38:39]
    s_waitcnt lgkmcnt(4)
    v_pk_add_f32 v[48:49], v[48:49], v[56:57]
    v_pk_add_f32 v[50:51], v[50:51], v[58:59]
    v_pk_add_f32 v[52:53], v[52:53], v[60:61]
    v_pk_add_f32 v[54:55], v[54:55], v[62:63]
    s_waitcnt lgkmcnt(0)
    v_pk_add_f32 v[64:65], v[64:65], v[72:73]
    v_pk_add_f32 v[66:67], v[66:67], v[74:75]
    v_pk_add_f32 v[68:69], v[68:69], v[76:77]
    v_pk_add_f32 v[70:71], v[70:71], v[78:79]
    v_pk_add_f32 v[104:105], v[48:49], v[64:65]
    v_pk_add_f32 v[106:107], v[50:51], v[66:67]
    v_pk_add_f32 v[108:109], v[52:53], v[68:69]
    v_pk_add_f32 v[110:111], v[54:55], v[70:71]
    s_lshl_b32 s3, s42, 11
    v_add_u32 v12, s3, v15
    v_add_u32 v12, 131072, v12
    ds_write_b128 v12, v[104:107] offset:0
    ds_write_b128 v12, v[108:111] offset:1024
    v_add_u32 v6, 0x10000, v6
    v_add_u32 v2, 0x10000, v2
    s_waitcnt lgkmcnt(0)
    s_barrier
    ds_read_b128 v[16:19], v6 offset:0
    ds_read_b128 v[20:23], v2 offset:0
    ds_read_b128 v[24:27], v6 offset:16384
    ds_read_b128 v[28:31], v2 offset:16384
    ds_read_b128 v[32:35], v6 offset:32768
    ds_read_b128 v[36:39], v2 offset:32768
    ds_read_b128 v[40:43], v6 offset:49152
    ds_read_b128 v[44:47], v2 offset:49152
    s_waitcnt lgkmcnt(4)
    v_pk_add_f32 v[16:17], v[16:17], v[24:25]
    v_pk_add_f32 v[18:19], v[18:19], v[26:27]
    v_pk_add_f32 v[20:21], v[20:21], v[28:29]
    v_pk_add_f32 v[22:23], v[22:23], v[30:31]
    v_pk_add_f32 v[16:17], v[16:17], v[96:97]
    v_pk_add_f32 v[18:19], v[18:19], v[98:99]
    v_pk_add_f32 v[20:21], v[20:21], v[100:101]
    v_pk_add_f32 v[22:23], v[22:23], v[102:103]
    s_waitcnt lgkmcnt(0)
    v_pk_add_f32 v[32:33], v[32:33], v[40:41]
    v_pk_add_f32 v[34:35], v[34:35], v[42:43]
    v_pk_add_f32 v[36:37], v[36:37], v[44:45]
    v_pk_add_f32 v[38:39], v[38:39], v[46:47]
    v_pk_add_f32 v[96:97], v[16:17], v[32:33]
    v_pk_add_f32 v[98:99], v[18:19], v[34:35]
    v_pk_add_f32 v[100:101], v[20:21], v[36:37]
    v_pk_add_f32 v[102:103], v[22:23], v[38:39]
    v_cvt_pk_bf16_f32 v16, v96, v97
    v_cvt_pk_bf16_f32 v17, v98, v99
    v_cvt_pk_bf16_f32 v18, v100, v101
    v_cvt_pk_bf16_f32 v19, v102, v103
    v_cndmask_b32_e64 v20, v16, v18, s[64:65]
    v_cndmask_b32_e64 v21, v17, v19, s[64:65]
    v_cndmask_b32_e64 v22, v18, v16, s[64:65]
    v_cndmask_b32_e64 v23, v19, v17, s[64:65]
    buffer_store_dwordx4 v[20:23], v7, s[28:31], s59 offen
    s_endpgm
L_slow_1005:
    s_nop 7
    s_waitcnt lgkmcnt(0)
    ds_read_b128 a[0:3], v12 offset:16384
    ds_read_b128 a[4:7], v12 offset:0
    ds_read_b128 a[8:11], v12 offset:14336
    s_waitcnt lgkmcnt(2)
    v_mfma_f32_32x32x16_bf16 v[16:31], a[0:3], v[120:123], 0
    ds_read_b128 a[0:3], v12 offset:12288
    s_waitcnt lgkmcnt(2)
    v_mfma_f32_32x32x16_bf16 v[32:47], a[4:7], v[120:123], 0
    ds_read_b128 a[4:7], v12 offset:10240
    s_waitcnt lgkmcnt(2)
    v_mfma_f32_32x32x16_bf16 v[48:63], a[8:11], v[120:123], 0
    ds_read_b128 a[8:11], v12 offset:8192
    s_nop 7
    v_cndmask_b32_e64 v16, v16, v32, s[64:65]
    v_cndmask_b32_e64 v17, v17, v33, s[66:67]
    v_cndmask_b32_e64 v18, v18, v34, s[68:69]
    v_cndmask_b32_e64 v19, v19, v35, s[70:71]
    v_cndmask_b32_e64 v20, v20, v36, s[72:73]
    v_cndmask_b32_e64 v21, v21, v37, s[74:75]
    v_cndmask_b32_e64 v22, v22, v38, s[76:77]
    v_cndmask_b32_e64 v23, v23, v39, s[78:79]
    v_cndmask_b32_e64 v24, v24, v40, s[80:81]
    v_cndmask_b32_e64 v25, v25, v41, s[82:83]
    v_cndmask_b32_e64 v26, v26, v42, s[84:85]
    v_cndmask_b32_e64 v27, v27, v43, s[86:87]
    v_cndmask_b32_e64 v28, v28, v44, s[88:89]
    v_cndmask_b32_e64 v29, v29, v45, s[90:91]
    v_cndmask_b32_e64 v30, v30, v46, s[92:93]
    v_cndmask_b32_e64 v31, v31, v47, s[94:95]
    s_waitcnt lgkmcnt(2)
    v_mfma_f32_32x32x16_bf16 v[32:47], a[0:3], v[120:123], 0
    ds_read_b128 a[0:3], v12 offset:6144
    v_max_f32 v80, v16, v17
    v_max_f32 v81, v18, v19
    v_max3_f32 v80, v20, v21, v80
    v_max3_f32 v81, v22, v23, v81
    v_max3_f32 v80, v24, v25, v80
    v_max3_f32 v81, v26, v27, v81
    v_max3_f32 v80, v28, v29, v80
    v_max3_f32 v81, v30, v31, v81
    s_waitcnt lgkmcnt(2)
    v_mfma_f32_32x32x16_bf16 v[16:31], a[4:7], v[120:123], 0
    ds_read_b128 a[4:7], v12 offset:4096
    v_max3_f32 v80, v48, v49, v80
    v_max3_f32 v81, v50, v51, v81
    v_max3_f32 v80, v52, v53, v80
    v_max3_f32 v81, v54, v55, v81
    v_max3_f32 v80, v56, v57, v80
    v_max3_f32 v81, v58, v59, v81
    v_max3_f32 v80, v60, v61, v80
    v_max3_f32 v81, v62, v63, v81
    s_waitcnt lgkmcnt(2)
    v_mfma_f32_32x32x16_bf16 v[48:63], a[8:11], v[120:123], 0
    ds_read_b128 a[8:11], v12 offset:2048
    v_max3_f32 v80, v32, v33, v80
    v_max3_f32 v81, v34, v35, v81
    v_max3_f32 v80, v36, v37, v80
    v_max3_f32 v81, v38, v39, v81
    v_max3_f32 v80, v40, v41, v80
    v_max3_f32 v81, v42, v43, v81
    v_max3_f32 v80, v44, v45, v80
    v_max3_f32 v81, v46, v47, v81
    s_waitcnt lgkmcnt(2)
    v_mfma_f32_32x32x16_bf16 v[32:47], a[0:3], v[120:123], 0
    ds_read_b128 a[0:3], v12 offset:16384
    v_max3_f32 v80, v16, v17, v80
    v_max3_f32 v81, v18, v19, v81
    v_max3_f32 v80, v20, v21, v80
    v_max3_f32 v81, v22, v23, v81
    v_max3_f32 v80, v24, v25, v80
    v_max3_f32 v81, v26, v27, v81
    v_max3_f32 v80, v28, v29, v80
    v_max3_f32 v81, v30, v31, v81
    s_waitcnt lgkmcnt(2)
    v_mfma_f32_32x32x16_bf16 v[16:31], a[4:7], v[120:123], 0
    ds_read_b128 a[4:7], v12 offset:0
    v_max3_f32 v80, v48, v49, v80
    v_max3_f32 v81, v50, v51, v81
    v_max3_f32 v80, v52, v53, v80
    v_max3_f32 v81, v54, v55, v81
    v_max3_f32 v80, v56, v57, v80
    v_max3_f32 v81, v58, v59, v81
    v_max3_f32 v80, v60, v61, v80
    v_max3_f32 v81, v62, v63, v81
    s_waitcnt lgkmcnt(2)
    v_mfma_f32_32x32x16_bf16 v[48:63], a[8:11], v[120:123], 0
    ds_read_b128 a[8:11], v12 offset:14336
    v_max3_f32 v80, v32, v33, v80
    v_max3_f32 v81, v34, v35, v81
    v_max3_f32 v80, v36, v37, v80
    v_max3_f32 v81, v38, v39, v81
    v_max3_f32 v80, v40, v41, v80
    v_max3_f32 v81, v42, v43, v81
    v_max3_f32 v80, v44, v45, v80
    v_max3_f32 v81, v46, v47, v81
    v_max3_f32 v80, v16, v17, v80
    v_max3_f32 v81, v18, v19, v81
    v_max3_f32 v80, v20, v21, v80
    v_max3_f32 v81, v22, v23, v81
    v_max3_f32 v80, v24, v25, v80
    v_max3_f32 v81, v26, v27, v81
    v_max3_f32 v80, v28, v29, v80
    v_max3_f32 v81, v30, v31, v81
    v_max3_f32 v80, v48, v49, v80
    v_max3_f32 v81, v50, v51, v81
    v_max3_f32 v80, v52, v53, v80
    v_max3_f32 v81, v54, v55, v81
    v_max3_f32 v80, v56, v57, v80
    v_max3_f32 v81, v58, v59, v81
    v_max3_f32 v80, v60, v61, v80
    v_max3_f32 v81, v62, v63, v81
    v_max_f32 v80, v80, v81
    v_mov_b32 v81, v80
    s_nop 1
    v_permlane32_swap_b32 v80, v81
    v_max_f32 v80, v80, v81
    v_sub_f32 v48, 0, v80
    v_sub_f32 v49, 0, v80
    v_mov_b64 v[50:51], v[48:49]
    v_mov_b64 v[52:53], v[48:49]
    v_mov_b64 v[54:55], v[48:49]
    v_mov_b64 v[56:57], v[48:49]
    v_mov_b64 v[58:59], v[48:49]
    v_mov_b64 v[60:61], v[48:49]
    v_mov_b64 v[62:63], v[48:49]
    s_waitcnt lgkmcnt(2)
    s_nop 0
    v_mfma_f32_32x32x16_bf16 v[16:31], a[0:3], v[120:123], v[48:63]
    ds_read_b128 a[0:3], v12 offset:12288
    s_waitcnt lgkmcnt(2)
    v_mfma_f32_32x32x16_bf16 v[32:47], a[4:7], v[120:123], v[48:63]
    ds_read_b128 a[4:7], v12 offset:10240
    ds_read_b128 a[12:15], v5 offset:16640
    ds_read_b128 a[16:19], v5 offset:17680
    ds_read_b128 a[20:23], v5 offset:0
    ds_read_b128 a[24:27], v5 offset:1040
    s_nop 6
    v_cndmask_b32_e64 v16, v16, v32, s[64:65]
    v_cndmask_b32_e64 v17, v17, v33, s[66:67]
    v_cndmask_b32_e64 v18, v18, v34, s[68:69]
    v_cndmask_b32_e64 v19, v19, v35, s[70:71]
    v_cndmask_b32_e64 v20, v20, v36, s[72:73]
    v_cndmask_b32_e64 v21, v21, v37, s[74:75]
    v_cndmask_b32_e64 v22, v22, v38, s[76:77]
    v_cndmask_b32_e64 v23, v23, v39, s[78:79]
    v_cndmask_b32_e64 v24, v24, v40, s[80:81]
    v_cndmask_b32_e64 v25, v25, v41, s[82:83]
    v_cndmask_b32_e64 v26, v26, v42, s[84:85]
    v_cndmask_b32_e64 v27, v27, v43, s[86:87]
    v_cndmask_b32_e64 v28, v28, v44, s[88:89]
    v_cndmask_b32_e64 v29, v29, v45, s[90:91]
    v_cndmask_b32_e64 v30, v30, v46, s[92:93]
    v_cndmask_b32_e64 v31, v31, v47, s[94:95]
    s_waitcnt lgkmcnt(6)
    v_mfma_f32_32x32x16_bf16 v[32:47], a[8:11], v[120:123], v[48:63]
    ds_read_b128 a[8:11], v12 offset:8192
    v_exp_f32 v16, v16
    v_exp_f32 v17, v17
    v_exp_f32 v18, v18
    v_exp_f32 v19, v19
    v_exp_f32 v20, v20
    v_exp_f32 v21, v21
    v_exp_f32 v22, v22
    v_exp_f32 v23, v23
    v_exp_f32 v24, v24
    v_exp_f32 v25, v25
    v_exp_f32 v26, v26
    v_exp_f32 v27, v27
    v_exp_f32 v28, v28
    v_exp_f32 v29, v29
    v_exp_f32 v30, v30
    v_exp_f32 v31, v31
    v_cvt_pk_bf16_f32 v96, v16, v17
    v_cvt_pk_bf16_f32 v97, v18, v19
    v_cvt_pk_bf16_f32 v98, v20, v21
    v_cvt_pk_bf16_f32 v99, v22, v23
    v_cvt_pk_bf16_f32 v100, v24, v25
    v_cvt_pk_bf16_f32 v101, v26, v27
    v_cvt_pk_bf16_f32 v102, v28, v29
    v_cvt_pk_bf16_f32 v103, v30, v31
    s_waitcnt lgkmcnt(6)
    v_mfma_f32_32x32x16_bf16 v[16:31], a[0:3], v[120:123], v[48:63]
    ds_read_b128 a[0:3], v12 offset:6144
    v_and_b32 v104, v96, v88
    v_and_b32 v105, v97, v89
    v_and_b32 v106, v98, v90
    v_and_b32 v107, v99, v91
    v_and_b32 v108, v100, v92
    v_and_b32 v109, v101, v93
    v_and_b32 v110, v102, v94
    v_and_b32 v111, v103, v95
    v_xor_b32 v96, v96, v104
    v_xor_b32 v97, v97, v105
    v_xor_b32 v98, v98, v106
    v_xor_b32 v99, v99, v107
    v_xor_b32 v100, v100, v108
    v_xor_b32 v101, v101, v109
    v_xor_b32 v102, v102, v110
    v_xor_b32 v103, v103, v111
    s_waitcnt lgkmcnt(3)
    v_mfma_f32_32x32x16_bf16 v[64:79], a[20:23], v[104:107], 0
    s_waitcnt lgkmcnt(2)
    v_mfma_f32_32x32x16_bf16 v[64:79], a[24:27], v[108:111], v[64:79]
    v_mfma_f32_32x32x16_bf16 v[64:79], a[12:15], v[96:99], v[64:79]
    v_mfma_f32_32x32x16_bf16 v[64:79], a[16:19], v[100:103], v[64:79]
    ds_read_b128 a[20:23], v5 offset:14560
    ds_read_b128 a[24:27], v5 offset:15600
    ds_read_b128 a[12:15], v5 offset:12480
    ds_read_b128 a[16:19], v5 offset:13520
    v_exp_f32 v32, v32
    v_exp_f32 v33, v33
    v_exp_f32 v34, v34
    v_exp_f32 v35, v35
    v_exp_f32 v36, v36
    v_exp_f32 v37, v37
    v_exp_f32 v38, v38
    v_exp_f32 v39, v39
    v_exp_f32 v40, v40
    v_exp_f32 v41, v41
    v_exp_f32 v42, v42
    v_exp_f32 v43, v43
    v_exp_f32 v44, v44
    v_exp_f32 v45, v45
    v_exp_f32 v46, v46
    v_exp_f32 v47, v47
    v_cvt_pk_bf16_f32 v104, v32, v33
    v_cvt_pk_bf16_f32 v105, v34, v35
    v_cvt_pk_bf16_f32 v106, v36, v37
    v_cvt_pk_bf16_f32 v107, v38, v39
    v_cvt_pk_bf16_f32 v108, v40, v41
    v_cvt_pk_bf16_f32 v109, v42, v43
    v_cvt_pk_bf16_f32 v110, v44, v45
    v_cvt_pk_bf16_f32 v111, v46, v47
    v_mfma_f32_32x32x16_bf16 v[32:47], a[4:7], v[120:123], v[48:63]
    ds_read_b128 a[4:7], v12 offset:4096
    s_waitcnt lgkmcnt(4)
    v_mfma_f32_32x32x16_bf16 v[64:79], a[20:23], v[104:107], v[64:79]
    s_waitcnt lgkmcnt(3)
    v_mfma_f32_32x32x16_bf16 v[64:79], a[24:27], v[108:111], v[64:79]
    ds_read_b128 a[20:23], v5 offset:10400
    ds_read_b128 a[24:27], v5 offset:11440
    v_exp_f32 v16, v16
    v_exp_f32 v17, v17
    v_exp_f32 v18, v18
    v_exp_f32 v19, v19
    v_exp_f32 v20, v20
    v_exp_f32 v21, v21
    v_exp_f32 v22, v22
    v_exp_f32 v23, v23
    v_exp_f32 v24, v24
    v_exp_f32 v25, v25
    v_exp_f32 v26, v26
    v_exp_f32 v27, v27
    v_exp_f32 v28, v28
    v_exp_f32 v29, v29
    v_exp_f32 v30, v30
    v_exp_f32 v31, v31
    v_cvt_pk_bf16_f32 v96, v16, v17
    v_cvt_pk_bf16_f32 v97, v18, v19
    v_cvt_pk_bf16_f32 v98, v20, v21
    v_cvt_pk_bf16_f32 v99, v22, v23
    v_cvt_pk_bf16_f32 v100, v24, v25
    v_cvt_pk_bf16_f32 v101, v26, v27
    v_cvt_pk_bf16_f32 v102, v28, v29
    v_cvt_pk_bf16_f32 v103, v30, v31
    v_mfma_f32_32x32x16_bf16 v[16:31], a[8:11], v[120:123], v[48:63]
    ds_read_b128 a[8:11], v12 offset:2048
    s_waitcnt lgkmcnt(5)
    v_mfma_f32_32x32x16_bf16 v[64:79], a[12:15], v[96:99], v[64:79]
    s_waitcnt lgkmcnt(4)
    v_mfma_f32_32x32x16_bf16 v[64:79], a[16:19], v[100:103], v[64:79]
    ds_read_b128 a[12:15], v5 offset:8320
    ds_read_b128 a[16:19], v5 offset:9360
    v_exp_f32 v32, v32
    v_exp_f32 v33, v33
    v_exp_f32 v34, v34
    v_exp_f32 v35, v35
    v_exp_f32 v36, v36
    v_exp_f32 v37, v37
    v_exp_f32 v38, v38
    v_exp_f32 v39, v39
    v_exp_f32 v40, v40
    v_exp_f32 v41, v41
    v_exp_f32 v42, v42
    v_exp_f32 v43, v43
    v_exp_f32 v44, v44
    v_exp_f32 v45, v45
    v_exp_f32 v46, v46
    v_exp_f32 v47, v47
    v_cvt_pk_bf16_f32 v104, v32, v33
    v_cvt_pk_bf16_f32 v105, v34, v35
    v_cvt_pk_bf16_f32 v106, v36, v37
    v_cvt_pk_bf16_f32 v107, v38, v39
    v_cvt_pk_bf16_f32 v108, v40, v41
    v_cvt_pk_bf16_f32 v109, v42, v43
    v_cvt_pk_bf16_f32 v110, v44, v45
    v_cvt_pk_bf16_f32 v111, v46, v47
    v_mfma_f32_32x32x16_bf16 v[32:47], a[0:3], v[120:123], v[48:63]
    s_waitcnt lgkmcnt(4)
    v_mfma_f32_32x32x16_bf16 v[64:79], a[20:23], v[104:107], v[64:79]
    s_waitcnt lgkmcnt(3)
    v_mfma_f32_32x32x16_bf16 v[64:79], a[24:27], v[108:111], v[64:79]
    ds_read_b128 a[20:23], v5 offset:6240
    ds_read_b128 a[24:27], v5 offset:7280
    v_exp_f32 v16, v16
    v_exp_f32 v17, v17
    v_exp_f32 v18, v18
    v_exp_f32 v19, v19
    v_exp_f32 v20, v20
    v_exp_f32 v21, v21
    v_exp_f32 v22, v22
    v_exp_f32 v23, v23
    v_exp_f32 v24, v24
    v_exp_f32 v25, v25
    v_exp_f32 v26, v26
    v_exp_f32 v27, v27
    v_exp_f32 v28, v28
    v_exp_f32 v29, v29
    v_exp_f32 v30, v30
    v_exp_f32 v31, v31
    v_cvt_pk_bf16_f32 v96, v16, v17
    v_cvt_pk_bf16_f32 v97, v18, v19
    v_cvt_pk_bf16_f32 v98, v20, v21
    v_cvt_pk_bf16_f32 v99, v22, v23
    v_cvt_pk_bf16_f32 v100, v24, v25
    v_cvt_pk_bf16_f32 v101, v26, v27
    v_cvt_pk_bf16_f32 v102, v28, v29
    v_cvt_pk_bf16_f32 v103, v30, v31
    v_mfma_f32_32x32x16_bf16 v[16:31], a[4:7], v[120:123], v[48:63]
    s_waitcnt lgkmcnt(3)
    v_mfma_f32_32x32x16_bf16 v[64:79], a[12:15], v[96:99], v[64:79]
    s_waitcnt lgkmcnt(2)
    v_mfma_f32_32x32x16_bf16 v[64:79], a[16:19], v[100:103], v[64:79]
    ds_read_b128 a[12:15], v5 offset:4160
    ds_read_b128 a[16:19], v5 offset:5200
    v_exp_f32 v32, v32
    v_exp_f32 v33, v33
    v_exp_f32 v34, v34
    v_exp_f32 v35, v35
    v_exp_f32 v36, v36
    v_exp_f32 v37, v37
    v_exp_f32 v38, v38
    v_exp_f32 v39, v39
    v_exp_f32 v40, v40
    v_exp_f32 v41, v41
    v_exp_f32 v42, v42
    v_exp_f32 v43, v43
    v_exp_f32 v44, v44
    v_exp_f32 v45, v45
    v_exp_f32 v46, v46
    v_exp_f32 v47, v47
    v_cvt_pk_bf16_f32 v104, v32, v33
    v_cvt_pk_bf16_f32 v105, v34, v35
    v_cvt_pk_bf16_f32 v106, v36, v37
    v_cvt_pk_bf16_f32 v107, v38, v39
    v_cvt_pk_bf16_f32 v108, v40, v41
    v_cvt_pk_bf16_f32 v109, v42, v43
    v_cvt_pk_bf16_f32 v110, v44, v45
    v_cvt_pk_bf16_f32 v111, v46, v47
    v_mfma_f32_32x32x16_bf16 v[32:47], a[8:11], v[120:123], v[48:63]
    s_waitcnt lgkmcnt(3)
    v_mfma_f32_32x32x16_bf16 v[64:79], a[20:23], v[104:107], v[64:79]
    s_waitcnt lgkmcnt(2)
    v_mfma_f32_32x32x16_bf16 v[64:79], a[24:27], v[108:111], v[64:79]
    ds_read_b128 a[20:23], v5 offset:2080
    ds_read_b128 a[24:27], v5 offset:3120
    v_exp_f32 v16, v16
    v_exp_f32 v17, v17
    v_exp_f32 v18, v18
    v_exp_f32 v19, v19
    v_exp_f32 v20, v20
    v_exp_f32 v21, v21
    v_exp_f32 v22, v22
    v_exp_f32 v23, v23
    v_exp_f32 v24, v24
    v_exp_f32 v25, v25
    v_exp_f32 v26, v26
    v_exp_f32 v27, v27
    v_exp_f32 v28, v28
    v_exp_f32 v29, v29
    v_exp_f32 v30, v30
    v_exp_f32 v31, v31
    v_cvt_pk_bf16_f32 v96, v16, v17
    v_cvt_pk_bf16_f32 v97, v18, v19
    v_cvt_pk_bf16_f32 v98, v20, v21
    v_cvt_pk_bf16_f32 v99, v22, v23
    v_cvt_pk_bf16_f32 v100, v24, v25
    v_cvt_pk_bf16_f32 v101, v26, v27
    v_cvt_pk_bf16_f32 v102, v28, v29
    v_cvt_pk_bf16_f32 v103, v30, v31
    s_waitcnt lgkmcnt(3)
    v_mfma_f32_32x32x16_bf16 v[64:79], a[12:15], v[96:99], v[64:79]
    s_waitcnt lgkmcnt(2)
    v_mfma_f32_32x32x16_bf16 v[64:79], a[16:19], v[100:103], v[64:79]
    v_exp_f32 v32, v32
    v_exp_f32 v33, v33
    v_exp_f32 v34, v34
    v_exp_f32 v35, v35
    v_exp_f32 v36, v36
    v_exp_f32 v37, v37
    v_exp_f32 v38, v38
    v_exp_f32 v39, v39
    v_exp_f32 v40, v40
    v_exp_f32 v41, v41
    v_exp_f32 v42, v42
    v_exp_f32 v43, v43
    v_exp_f32 v44, v44
    v_exp_f32 v45, v45
    v_exp_f32 v46, v46
    v_exp_f32 v47, v47
    v_cvt_pk_bf16_f32 v104, v32, v33
    v_cvt_pk_bf16_f32 v105, v34, v35
    v_cvt_pk_bf16_f32 v106, v36, v37
    v_cvt_pk_bf16_f32 v107, v38, v39
    v_cvt_pk_bf16_f32 v108, v40, v41
    v_cvt_pk_bf16_f32 v109, v42, v43
    v_cvt_pk_bf16_f32 v110, v44, v45
    v_cvt_pk_bf16_f32 v111, v46, v47
    s_waitcnt lgkmcnt(1)
    v_mfma_f32_32x32x16_bf16 v[64:79], a[20:23], v[104:107], v[64:79]
    s_waitcnt lgkmcnt(0)
    v_mfma_f32_32x32x16_bf16 v[64:79], a[24:27], v[108:111], v[64:79]
    s_nop 15
    s_branch L_back_1006
.p2align 6
L_hd1:
    s_mov_b64 s[12:13], s[74:75]
    s_mov_b32 s14, 0x158000
    s_mov_b32 s15, 0x20000
    s_mov_b64 s[24:25], s[84:85]
    s_mov_b32 s26, 0x1000000
    s_mov_b32 s27, 0x20000
    s_mov_b64 s[32:33], s[82:83]
    s_mov_b32 s34, 0x100
    s_mov_b32 s35, 0x20000
    s_mov_b64 s[16:17], s[76:77]
    s_mov_b32 s18, 0x158000
    s_mov_b32 s19, 0x20000
    s_mov_b64 s[20:21], s[68:69]
    s_mov_b32 s22, 0x80000
    s_mov_b32 s23, 0x20000
    s_mov_b64 s[28:29], s[80:81]
    s_mov_b32 s30, 0x200000
    s_mov_b32 s31, 0x20000
    v_and_b32 v124, 15, v0
    v_lshrrev_b32 v125, 4, v0
    v_bfe_u32 v5, v0, 1, 3
    v_xor_b32 v5, v5, v125
    v_lshlrev_b32 v5, 4, v5
    v_lshl_add_u32 v5, v124, 7, v5
    v_add_u32 v4, s48, v5
    v_xor_b32 v5, 64, v4
    v_bfe_u32 v124, v0, 4, 1
    v_bfe_u32 v125, v0, 2, 2
    v_lshlrev_b32 v125, 6, v125
    v_mul_u32_u24 v2, 544, v124
    v_add_u32 v125, v125, v2
    v_lshrrev_b32 v124, 5, v0
    v_mul_u32_u24 v124, 3072, v124
    v_add_u32 v125, v125, v124
    v_and_b32 v6, 1, v0
    v_lshl_add_u32 v125, v6, 4, v125
    v_bfe_u32 v6, v0, 1, 1
    v_lshl_add_u32 v6, v6, 3, v125
    v_xor_b32 v6, 32, v6
    v_add_u32 v2, v124, v6
    v_and_b32 v124, 14, v0
    v_cmp_eq_u32 vcc, 0, v124
    v_and_b32 v124, 1, v0
    v_lshrrev_b32 v125, 4, v0
    v_lshl_add_u32 v124, v124, 2, v125
    v_lshlrev_b32 v124, 4, v124
    v_mov_b32 v125, 1024
    v_cndmask_b32_e64 v12, v125, v124, vcc
    s_lshr_b32 s52, s41, 2
    s_mul_i32 s52, s52, 11
    s_and_b32 s53, s41, 3
    s_mul_i32 s54, s53, 3
    s_add_u32 s96, s52, s54
    s_cmp_eq_u32 s41, 15
    s_subb_u32 s96, s96, 0
    s_cmp_eq_u32 s53, 3
    s_cselect_b32 s97, 0x40000000, 0
    s_cmp_eq_u32 s41, 14
    s_cselect_b32 s97, 0x40000000, s97
    v_add_u32 v14, s97, v13
    s_mul_i32 s47, s42, 44032
    s_lshl_b32 s3, s96, 6
    s_add_u32 s47, s47, s3
    s_mul_i32 s50, s42, 6144
    s_lshl_b32 s51, s42, 11
    s_mul_i32 s61, s42, 2080
    s_mul_i32 s52, s98, 120832
    s_lshl_b32 s3, s96, 11
    s_add_u32 s57, s52, s3
    s_add_u32 s57, s57, 8389632
    s_lshl_b32 s53, s41, 6
    s_add_u32 s3, s53, s98
    s_lshl_b32 s56, s3, 12
    s_add_u32 s56, s56, 1048576
    s_lshl_b32 s0, s3, 7
    s_add_u32 s0, s0, 5242944
    s_lshl4_add_u32 s1, s98, s41
    s_lshl_b32 s1, s1, 7
    s_add_u32 s1, s1, 5505088
    s_lshl_b32 s3, s41, 11
    s_add_u32 s41, s52, s3
    s_add_u32 s41, s41, 8477696
    s_lshl_b32 s3, s40, 2
    s_add_u32 s3, s3, 3
    v_lshrrev_b32 v124, 1, v0
    v_cmp_ge_u32 vcc, s3, v124
    v_mov_b32 v124, 0x3f803f80
    s_nop 0
    v_cndmask_b32_e64 v126, 0, v124, vcc
    s_sub_u32 s3, s98, 4
    s_cselect_b32 s40, 0x40000000, 0
    s_cselect_b32 s98, 0x200, -1
    s_max_i32 s3, s3, 0
    s_add_u32 s3, s3, s53
    s_lshl_b32 s99, s3, 12
    s_add_u32 s99, s99, 1048576
    s_lshl_b32 s96, s3, 7
    s_add_u32 s96, s96, 5242880
    s_and_b32 s52, s2, 7
    s_bfe_u32 s54, s2, 0x30003
    s_lshr_b32 s59, s2, 6
    s_and_b32 s3, s2, 1
    s_lshl2_add_u32 s59, s3, s59
    s_lshr_b32 s52, s52, 1
    s_lshl3_add_u32 s58, s52, s54
    s_lshl_b32 s58, s58, 1
    s_cmp_ge_u32 s52, 3
    s_cselect_b32 s62, 0, s52
    s_mul_i32 s3, s42, 22
    s_add_u32 s3, s3, 14
    s_lshl_b32 s36, s3, 14
    s_lshl_b32 s52, s59, 7
    s_add_u32 s36, s36, s52
    s_lshl_b32 s3, s3, 10
    s_mul_i32 s38, s58, 120832
    s_add_u32 s38, s38, 8388608
    s_add_u32 s37, s38, s3
    s_lshl_b32 s60, s42, 17
    s_add_u32 s60, s60, s52
    s_lshl_b32 s3, s42, 13
    s_add_u32 s38, s38, s3
    s_add_u32 s38, s38, 88064
    s_lshl2_add_u32 s3, s58, s42
    s_lshl_b32 s59, s3, 13
    s_add_u32 s59, s59, s52
    s_lshl_b32 s58, s3, 9
    s_add_u32 s58, s58, 5505024
    v_and_b32 v124, 31, v0
    v_lshrrev_b32 v125, 5, v0
    v_lshlrev_b32 v125, 2, v125
    v_sub_u32 v124, v124, v125
    v_cmp_le_i32_e64 s[64:65], 0, v124
    v_cmp_le_i32_e64 s[66:67], 1, v124
    v_cmp_le_i32_e64 s[68:69], 2, v124
    v_cmp_le_i32_e64 s[70:71], 3, v124
    v_cmp_le_i32_e64 s[72:73], 8, v124
    v_cmp_le_i32_e64 s[74:75], 9, v124
    v_cmp_le_i32_e64 s[76:77], 10, v124
    v_cmp_le_i32_e64 s[78:79], 11, v124
    v_cmp_le_i32_e64 s[80:81], 16, v124
    v_cmp_le_i32_e64 s[82:83], 17, v124
    v_cmp_le_i32_e64 s[84:85], 18, v124
    v_cmp_le_i32_e64 s[86:87], 19, v124
    v_cmp_le_i32_e64 s[88:89], 24, v124
    v_cmp_le_i32_e64 s[90:91], 25, v124
    v_cmp_le_i32_e64 s[92:93], 26, v124
    v_cmp_le_i32_e64 s[94:95], 27, v124
    v_mov_b32 v44, 0xffff
    v_mov_b32 v45, 0xffff0000
    v_cndmask_b32_e64 v46, 0, v44, s[64:65]
    v_cndmask_b32_e64 v24, 0, v45, s[66:67]
    v_or_b32 v24, v46, v24
    v_cndmask_b32_e64 v46, 0, v44, s[68:69]
    v_cndmask_b32_e64 v25, 0, v45, s[70:71]
    v_or_b32 v25, v46, v25
    v_cndmask_b32_e64 v46, 0, v44, s[72:73]
    v_cndmask_b32_e64 v26, 0, v45, s[74:75]
    v_or_b32 v26, v46, v26
    v_cndmask_b32_e64 v46, 0, v44, s[76:77]
    v_cndmask_b32_e64 v27, 0, v45, s[78:79]
    v_or_b32 v27, v46, v27
    v_cndmask_b32_e64 v46, 0, v44, s[80:81]
    v_cndmask_b32_e64 v28, 0, v45, s[82:83]
    v_or_b32 v28, v46, v28
    v_cndmask_b32_e64 v46, 0, v44, s[84:85]
    v_cndmask_b32_e64 v29, 0, v45, s[86:87]
    v_or_b32 v29, v46, v29
    v_cndmask_b32_e64 v46, 0, v44, s[88:89]
    v_cndmask_b32_e64 v30, 0, v45, s[90:91]
    v_or_b32 v30, v46, v30
    v_cndmask_b32_e64 v46, 0, v44, s[92:93]
    v_cndmask_b32_e64 v31, 0, v45, s[94:95]
    v_or_b32 v31, v46, v31
    v_lshrrev_b32 v44, 5, v0
    v_bfe_u32 v45, v0, 2, 2
    v_lshl_add_u32 v44, v44, 2, v45
    v_lshlrev_b32 v44, 7, v44
    v_bfe_u32 v45, v0, 3, 1
    v_lshl_add_u32 v44, v45, 6, v44
    v_bfe_u32 v45, v0, 4, 1
    v_lshl_add_u32 v44, v45, 5, v44
    v_and_b32 v45, 3, v0
    v_lshl_add_u32 v32, v45, 3, v44
    v_and_b32 v44, 16, v0
    v_cmp_eq_u32 vcc, 0, v44
    v_add_u32 v44, 31072, v15
    v_mov_b32 v45, 31840
    v_cndmask_b32_e64 v33, v45, v44, vcc
    v_lshrrev_b32 v44, 4, v0
    v_bfe_u32 v45, v0, 3, 1
    v_lshl_add_u32 v35, v45, 2, v44
    v_lshlrev_b32 v44, 8, v44
    v_lshl_add_u32 v44, v45, 7, v44
    v_and_b32 v45, 7, v0
    v_lshlrev_b32 v45, 4, v45
    v_lshl_add_u32 v35, v35, 10, v45
    v_and_b32 v45, 3, v0
    v_lshl_add_u32 v44, v45, 5, v44
    v_bfe_u32 v45, v0, 2, 1
    v_mul_u32_u24 v45, 4112, v45
    v_add_u32 v34, v44, v45
    v_bfe_u32 v44, v0, 4, 1
    v_lshlrev_b32 v44, 2, v44
    v_and_b32 v45, 7, v0
    v_xor_b32 v44, v44, v45
    v_lshlrev_b32 v44, 4, v44
    v_lshrrev_b32 v45, 3, v0
    v_lshl_add_u32 v36, v45, 10, v44
    s_lshr_b32 s3, s2, 3
    s_lshl_b32 s3, s3, 14
    s_add_u32 s3, s3, 8192
    s_and_b32 s52, s2, 1
    s_lshl_b32 s52, s52, 9
    s_add_u32 s3, s3, s52
    v_and_b32 v44, 3, v0
    v_lshl_add_u32 v44, v44, 7, s3
    v_bfe_u32 v45, v0, 2, 1
    v_lshl_add_u32 v44, v45, 10, v44
    v_cmp_gt_u32 vcc, 8, v0
    v_mov_b32 v45, 0x40000000
    s_nop 0
    v_cndmask_b32_e64 v37, v45, v44, vcc
    v_bfe_u32 v44, v0, 3, 1
    v_and_b32 v45, 1, v0
    v_lshl_add_u32 v44, v44, 5, v45
    v_bfe_u32 v45, v0, 1, 2
    v_lshl_add_u32 v39, v45, 1, v44
    v_lshlrev_b32 v39, 6, v39
    v_add_u32 v39, 262144, v39
    v_max_u32 v45, 2, v45
    v_lshl_add_u32 v38, v45, 1, v44
    v_lshlrev_b32 v38, 6, v38
    ds_write_b128 v15, v[24:27] offset:19456
    ds_write_b128 v15, v[28:31] offset:20480
    ds_write_b128 v15, v[32:35] offset:21504
    ds_write_b128 v15, v[36:39] offset:22528
    s_add_u32 s52, s43, 1
    s_and_b32 s52, s52, 7
    s_lshl_b32 s53, s52, 7
    s_add_u32 m0, s48, 79872
    s_add_u32 s53, s53, s45
    buffer_load_dwordx4 v8, s[4:7], s53 offen lds
    s_add_u32 m0, s48, 80896
    s_mul_i32 s54, s52, 196608
    buffer_load_dwordx4 v9, s[4:7], s53 offen lds
    s_add_u32 m0, s49, 94208
    s_add_u32 s54, s54, s46
    buffer_load_dwordx4 v10, s[8:11], s54 offen offset:0 lds
    s_waitcnt vmcnt(3) lgkmcnt(0)
    s_barrier
    ds_read_b128 a[0:3], v4 offset:49152
    ds_read_b128 a[4:7], v4 offset:51200
    v_add_u32 v6, 0x10000, v6
    ds_read_b64_tr_b16 v[96:97], v6 offset:0
    ds_read_b64_tr_b16 v[98:99], v6 offset:256
    ds_read_b64_tr_b16 v[100:101], v6 offset:1024
    ds_read_b64_tr_b16 v[102:103], v6 offset:1280
    ds_read_b128 v[16:19], v12 offset:16384
    ds_read_b128 a[8:11], v5 offset:49152
    ds_read_b128 a[12:15], v5 offset:51200
    ds_read_b64_tr_b16 v[108:109], v6 offset:6144
    ds_read_b64_tr_b16 v[110:111], v6 offset:6400
    ds_read_b64_tr_b16 v[112:113], v6 offset:7168
    ds_read_b64_tr_b16 v[114:115], v6 offset:7424
    s_waitcnt lgkmcnt(9)
    v_mfma_f32_16x16x32_bf16 v[64:67], v[96:99], a[0:3], 0
    v_mfma_f32_16x16x32_bf16 v[68:71], v[96:99], a[4:7], 0
    s_add_u32 s52, s43, 2
    s_and_b32 s52, s52, 7
    s_lshl_b32 s53, s52, 7
    s_add_u32 m0, s48, 108544
    s_add_u32 s53, s53, s45
    buffer_load_dwordx4 v8, s[4:7], s53 offen lds
    s_waitcnt lgkmcnt(7)
    v_mfma_f32_16x16x32_bf16 v[72:75], v[100:103], a[0:3], 0
    v_mfma_f32_16x16x32_bf16 v[76:79], v[100:103], a[4:7], 0
    s_add_u32 m0, s48, 109568
    s_mul_i32 s54, s52, 196608
    buffer_load_dwordx4 v9, s[4:7], s53 offen lds
    s_add_u32 m0, s49, 122880
    s_add_u32 s54, s54, s46
    buffer_load_dwordx4 v10, s[8:11], s54 offen offset:0 lds
    s_add_u32 s52, s43, 3
    s_and_b32 s52, s52, 7
    s_lshl_b32 s53, s52, 7
    s_add_u32 m0, s48, 137216
    s_add_u32 s53, s53, s45
    buffer_load_dwordx4 v8, s[4:7], s53 offen lds
    s_add_u32 m0, s48, 138240
    s_mul_i32 s54, s52, 196608
    buffer_load_dwordx4 v9, s[4:7], s53 offen lds
    s_add_u32 m0, s49, 151552
    s_add_u32 s54, s54, s46
    buffer_load_dwordx4 v10, s[8:11], s54 offen offset:0 lds
    s_waitcnt vmcnt(6) lgkmcnt(0)
    s_barrier
    v_mfma_f32_16x16x32_bf16 v[80:83], v[16:19], a[0:3], 0
    v_add_u32 v4, 0x13000, v4
    ds_read_b128 a[16:19], v4 offset:0
    v_mfma_f32_16x16x32_bf16 v[84:87], v[16:19], a[4:7], 0
    ds_read_b128 a[20:23], v4 offset:2048
    ds_read_b64_tr_b16 v[96:97], v6 offset:28672
    ds_read_b64_tr_b16 v[98:99], v6 offset:28928
    ds_read_b64_tr_b16 v[100:101], v6 offset:29696
    ds_read_b64_tr_b16 v[102:103], v6 offset:29952
    s_add_u32 s52, s43, 4
    s_and_b32 s52, s52, 7
    s_lshl_b32 s53, s52, 7
    s_add_u32 m0, s48, 51200
    s_add_u32 s53, s53, s45
    buffer_load_dwordx4 v8, s[4:7], s53 offen lds
    v_mfma_f32_16x16x32_bf16 v[64:67], v[108:111], a[8:11], v[64:67]
    ds_read_b128 v[120:123], v12 offset:16512
    v_mfma_f32_16x16x32_bf16 v[68:71], v[108:111], a[12:15], v[68:71]
    v_mfma_f32_16x16x32_bf16 v[72:75], v[112:115], a[8:11], v[72:75]
    v_add_u32 v5, 0x13000, v5
    ds_read_b128 a[24:27], v5 offset:0
    v_mfma_f32_16x16x32_bf16 v[76:79], v[112:115], a[12:15], v[76:79]
    ds_read_b128 a[28:31], v5 offset:2048
    ds_read_b64_tr_b16 v[108:109], v6 offset:34816
    ds_read_b64_tr_b16 v[110:111], v6 offset:35072
    s_add_u32 m0, s48, 52224
    s_mul_i32 s54, s52, 196608
    buffer_load_dwordx4 v9, s[4:7], s53 offen lds
    v_mfma_f32_16x16x32_bf16 v[88:91], v[16:19], a[8:11], 0
    ds_read_b64_tr_b16 v[112:113], v6 offset:35840
    v_mfma_f32_16x16x32_bf16 v[92:95], v[16:19], a[12:15], 0
    ds_read_b64_tr_b16 v[114:115], v6 offset:36096
    s_add_u32 m0, s49, 65536
    s_add_u32 s54, s54, s46
    buffer_load_dwordx4 v10, s[8:11], s54 offen offset:0 lds
    s_waitcnt lgkmcnt(9)
    v_mfma_f32_16x16x32_bf16 v[64:67], v[96:99], a[16:19], v[64:67]
    v_mfma_f32_16x16x32_bf16 v[68:71], v[96:99], a[20:23], v[68:71]
    s_waitcnt lgkmcnt(7)
    v_mfma_f32_16x16x32_bf16 v[72:75], v[100:103], a[16:19], v[72:75]
    v_mfma_f32_16x16x32_bf16 v[76:79], v[100:103], a[20:23], v[76:79]
    s_waitcnt vmcnt(6) lgkmcnt(0)
    s_barrier
    v_mfma_f32_16x16x32_bf16 v[80:83], v[120:123], a[16:19], v[80:83]
    ds_read_b128 a[32:35], v4 offset:28672
    v_mfma_f32_16x16x32_bf16 v[84:87], v[120:123], a[20:23], v[84:87]
    ds_read_b128 a[36:39], v4 offset:30720
    ds_read_b64_tr_b16 v[96:97], v6 offset:57344
    ds_read_b64_tr_b16 v[98:99], v6 offset:57600
    ds_read_b64_tr_b16 v[100:101], v6 offset:58368
    ds_read_b64_tr_b16 v[102:103], v6 offset:58624
    s_add_u32 s52, s43, 5
    s_and_b32 s52, s52, 7
    s_lshl_b32 s53, s52, 7
    s_add_u32 m0, s48, 79872
    s_add_u32 s53, s53, s45
    buffer_load_dwordx4 v8, s[4:7], s53 offen lds
    v_mfma_f32_16x16x32_bf16 v[64:67], v[108:111], a[24:27], v[64:67]
    ds_read_b128 v[16:19], v12 offset:16640
    v_mfma_f32_16x16x32_bf16 v[68:71], v[108:111], a[28:31], v[68:71]
    v_mfma_f32_16x16x32_bf16 v[72:75], v[112:115], a[24:27], v[72:75]
    ds_read_b128 a[40:43], v5 offset:28672
    v_mfma_f32_16x16x32_bf16 v[76:79], v[112:115], a[28:31], v[76:79]
    ds_read_b128 a[44:47], v5 offset:30720
    ds_read_b64_tr_b16 v[108:109], v6 offset:63488
    ds_read_b64_tr_b16 v[110:111], v6 offset:63744
    s_add_u32 m0, s48, 80896
    s_mul_i32 s54, s52, 196608
    buffer_load_dwordx4 v9, s[4:7], s53 offen lds
    v_mfma_f32_16x16x32_bf16 v[88:91], v[120:123], a[24:27], v[88:91]
    ds_read_b64_tr_b16 v[112:113], v6 offset:64512
    v_mfma_f32_16x16x32_bf16 v[92:95], v[120:123], a[28:31], v[92:95]
    ds_read_b64_tr_b16 v[114:115], v6 offset:64768
    s_add_u32 m0, s49, 94208
    s_add_u32 s54, s54, s46
    buffer_load_dwordx4 v10, s[8:11], s54 offen offset:0 lds
    s_waitcnt lgkmcnt(9)
    v_mfma_f32_16x16x32_bf16 v[64:67], v[96:99], a[32:35], v[64:67]
    v_mfma_f32_16x16x32_bf16 v[68:71], v[96:99], a[36:39], v[68:71]
    s_waitcnt lgkmcnt(7)
    v_mfma_f32_16x16x32_bf16 v[72:75], v[100:103], a[32:35], v[72:75]
    v_mfma_f32_16x16x32_bf16 v[76:79], v[100:103], a[36:39], v[76:79]
    s_waitcnt vmcnt(6) lgkmcnt(0)
    s_barrier
    v_mfma_f32_16x16x32_bf16 v[80:83], v[16:19], a[32:35], v[80:83]
    ds_read_b128 a[48:51], v4 offset:57344
    v_mfma_f32_16x16x32_bf16 v[84:87], v[16:19], a[36:39], v[84:87]
    ds_read_b128 a[52:55], v4 offset:59392
    v_add_u32 v6, 0x15000, v6
    ds_read_b64_tr_b16 v[96:97], v6 offset:0
    ds_read_b64_tr_b16 v[98:99], v6 offset:256
    ds_read_b64_tr_b16 v[100:101], v6 offset:1024
    ds_read_b64_tr_b16 v[102:103], v6 offset:1280
    s_add_u32 s52, s43, 6
    s_and_b32 s52, s52, 7
    s_lshl_b32 s53, s52, 7
    s_add_u32 m0, s48, 108544
    s_add_u32 s53, s53, s45
    buffer_load_dwordx4 v8, s[4:7], s53 offen lds
    v_mfma_f32_16x16x32_bf16 v[64:67], v[108:111], a[40:43], v[64:67]
    ds_read_b128 v[120:123], v12 offset:16768
    v_mfma_f32_16x16x32_bf16 v[68:71], v[108:111], a[44:47], v[68:71]
    v_mfma_f32_16x16x32_bf16 v[72:75], v[112:115], a[40:43], v[72:75]
    ds_read_b128 a[56:59], v5 offset:57344
    v_mfma_f32_16x16x32_bf16 v[76:79], v[112:115], a[44:47], v[76:79]
    ds_read_b128 a[60:63], v5 offset:59392
    ds_read_b64_tr_b16 v[108:109], v6 offset:6144
    ds_read_b64_tr_b16 v[110:111], v6 offset:6400
    s_add_u32 m0, s48, 109568
    s_mul_i32 s54, s52, 196608
    buffer_load_dwordx4 v9, s[4:7], s53 offen lds
    v_mfma_f32_16x16x32_bf16 v[88:91], v[16:19], a[40:43], v[88:91]
    ds_read_b64_tr_b16 v[112:113], v6 offset:7168
    v_mfma_f32_16x16x32_bf16 v[92:95], v[16:19], a[44:47], v[92:95]
    ds_read_b64_tr_b16 v[114:115], v6 offset:7424
    s_add_u32 m0, s49, 122880
    s_add_u32 s54, s54, s46
    buffer_load_dwordx4 v10, s[8:11], s54 offen offset:0 lds
    s_waitcnt lgkmcnt(9)
    v_mfma_f32_16x16x32_bf16 v[64:67], v[96:99], a[48:51], v[64:67]
    v_mfma_f32_16x16x32_bf16 v[68:71], v[96:99], a[52:55], v[68:71]
    s_waitcnt lgkmcnt(7)
    v_mfma_f32_16x16x32_bf16 v[72:75], v[100:103], a[48:51], v[72:75]
    v_mfma_f32_16x16x32_bf16 v[76:79], v[100:103], a[52:55], v[76:79]
    s_waitcnt vmcnt(6) lgkmcnt(0)
    s_barrier
    v_mfma_f32_16x16x32_bf16 v[80:83], v[120:123], a[48:51], v[80:83]
    v_add_u32 v4, 0xffff9000, v4
    ds_read_b128 a[64:67], v4 offset:0
    v_mfma_f32_16x16x32_bf16 v[84:87], v[120:123], a[52:55], v[84:87]
    ds_read_b128 a[68:71], v4 offset:2048
    v_add_u32 v6, 0xfffeb000, v6
    ds_read_b64_tr_b16 v[96:97], v6 offset:0
    ds_read_b64_tr_b16 v[98:99], v6 offset:256
    ds_read_b64_tr_b16 v[100:101], v6 offset:1024
    ds_read_b64_tr_b16 v[102:103], v6 offset:1280
    s_add_u32 s52, s43, 7
    s_and_b32 s52, s52, 7
    s_lshl_b32 s53, s52, 7
    s_add_u32 m0, s48, 137216
    s_add_u32 s53, s53, s45
    buffer_load_dwordx4 v8, s[4:7], s53 offen lds
    v_mfma_f32_16x16x32_bf16 v[64:67], v[108:111], a[56:59], v[64:67]
    ds_read_b128 v[16:19], v12 offset:16896
    v_mfma_f32_16x16x32_bf16 v[68:71], v[108:111], a[60:63], v[68:71]
    v_mfma_f32_16x16x32_bf16 v[72:75], v[112:115], a[56:59], v[72:75]
    v_add_u32 v5, 0xffff9000, v5
    ds_read_b128 a[72:75], v5 offset:0
    v_mfma_f32_16x16x32_bf16 v[76:79], v[112:115], a[60:63], v[76:79]
    ds_read_b128 a[76:79], v5 offset:2048
    ds_read_b64_tr_b16 v[108:109], v6 offset:6144
    ds_read_b64_tr_b16 v[110:111], v6 offset:6400
    s_add_u32 m0, s48, 138240
    s_mul_i32 s54, s52, 196608
    buffer_load_dwordx4 v9, s[4:7], s53 offen lds
    v_mfma_f32_16x16x32_bf16 v[88:91], v[120:123], a[56:59], v[88:91]
    ds_read_b64_tr_b16 v[112:113], v6 offset:7168
    v_mfma_f32_16x16x32_bf16 v[92:95], v[120:123], a[60:63], v[92:95]
    ds_read_b64_tr_b16 v[114:115], v6 offset:7424
    s_add_u32 m0, s49, 151552
    s_add_u32 s54, s54, s46
    buffer_load_dwordx4 v10, s[8:11], s54 offen offset:0 lds
    s_waitcnt lgkmcnt(9)
    v_mfma_f32_16x16x32_bf16 v[64:67], v[96:99], a[64:67], v[64:67]
    v_mfma_f32_16x16x32_bf16 v[68:71], v[96:99], a[68:71], v[68:71]
    s_waitcnt lgkmcnt(7)
    v_mfma_f32_16x16x32_bf16 v[72:75], v[100:103], a[64:67], v[72:75]
    v_mfma_f32_16x16x32_bf16 v[76:79], v[100:103], a[68:71], v[76:79]
    s_waitcnt vmcnt(6) lgkmcnt(0)
    s_barrier
    v_mfma_f32_16x16x32_bf16 v[80:83], v[16:19], a[64:67], v[80:83]
    ds_read_b128 a[80:83], v4 offset:28672
    v_mfma_f32_16x16x32_bf16 v[84:87], v[16:19], a[68:71], v[84:87]
    ds_read_b128 a[84:87], v4 offset:30720
    ds_read_b64_tr_b16 v[96:97], v6 offset:28672
    ds_read_b64_tr_b16 v[98:99], v6 offset:28928
    ds_read_b64_tr_b16 v[100:101], v6 offset:29696
    ds_read_b64_tr_b16 v[102:103], v6 offset:29952
    s_add_u32 s52, s43, 8
    s_and_b32 s52, s52, 7
    s_mul_i32 s54, s52, 176128
    s_add_u32 m0, s50, 54272
    s_add_u32 s54, s54, s47
    buffer_load_dwordx4 v13, s[12:15], s54 offen offset:0 lds
    ds_read_b128 v[8:11], v15 offset:22528
    v_mfma_f32_16x16x32_bf16 v[64:67], v[108:111], a[72:75], v[64:67]
    ds_read_b128 v[120:123], v12 offset:17024
    v_mfma_f32_16x16x32_bf16 v[68:71], v[108:111], a[76:79], v[68:71]
    v_mfma_f32_16x16x32_bf16 v[72:75], v[112:115], a[72:75], v[72:75]
    ds_read_b128 a[88:91], v5 offset:28672
    v_mfma_f32_16x16x32_bf16 v[76:79], v[112:115], a[76:79], v[76:79]
    ds_read_b128 a[92:95], v5 offset:30720
    ds_read_b64_tr_b16 v[108:109], v6 offset:34816
    ds_read_b64_tr_b16 v[110:111], v6 offset:35072
    s_add_u32 m0, s50, 56256
    s_nop 0
    buffer_load_dwordx4 v13, s[12:15], s54 offen offset:64 lds
    v_mfma_f32_16x16x32_bf16 v[88:91], v[16:19], a[72:75], v[88:91]
    ds_read_b64_tr_b16 v[112:113], v6 offset:35840
    v_mfma_f32_16x16x32_bf16 v[92:95], v[16:19], a[76:79], v[92:95]
    ds_read_b64_tr_b16 v[114:115], v6 offset:36096
    s_add_u32 m0, s50, 58240
    s_nop 0
    buffer_load_dwordx4 v14, s[12:15], s54 offen offset:128 lds
    s_waitcnt lgkmcnt(10)
    v_mfma_f32_16x16x32_bf16 v[64:67], v[96:99], a[80:83], v[64:67]
    v_mfma_f32_16x16x32_bf16 v[68:71], v[96:99], a[84:87], v[68:71]
    s_waitcnt lgkmcnt(8)
    v_mfma_f32_16x16x32_bf16 v[72:75], v[100:103], a[80:83], v[72:75]
    v_mfma_f32_16x16x32_bf16 v[76:79], v[100:103], a[84:87], v[76:79]
    s_waitcnt vmcnt(6) lgkmcnt(0)
    s_barrier
    v_mfma_f32_16x16x32_bf16 v[80:83], v[120:123], a[80:83], v[80:83]
    ds_read_b128 a[96:99], v4 offset:57344
    v_mfma_f32_16x16x32_bf16 v[84:87], v[120:123], a[84:87], v[84:87]
    ds_read_b128 a[100:103], v4 offset:59392
    ds_read_b64_tr_b16 v[96:97], v6 offset:57344
    ds_read_b64_tr_b16 v[98:99], v6 offset:57600
    ds_read_b64_tr_b16 v[100:101], v6 offset:58368
    ds_read_b64_tr_b16 v[102:103], v6 offset:58624
    s_add_u32 s52, s43, 9
    s_and_b32 s52, s52, 7
    s_mul_i32 s54, s52, 176128
    s_add_u32 m0, s50, 82944
    s_add_u32 s54, s54, s47
    buffer_load_dwordx4 v13, s[12:15], s54 offen offset:0 lds
    s_lshl_b32 s3, s42, 11
    v_add_u32 v9, s3, v9
    v_mfma_f32_16x16x32_bf16 v[64:67], v[108:111], a[88:91], v[64:67]
    ds_read_b128 v[16:19], v12 offset:17152
    v_mfma_f32_16x16x32_bf16 v[68:71], v[108:111], a[92:95], v[68:71]
    v_mfma_f32_16x16x32_bf16 v[72:75], v[112:115], a[88:91], v[72:75]
    ds_read_b128 a[104:107], v5 offset:57344
    v_mfma_f32_16x16x32_bf16 v[76:79], v[112:115], a[92:95], v[76:79]
    ds_read_b128 a[108:111], v5 offset:59392
    ds_read_b64_tr_b16 v[108:109], v6 offset:63488
    ds_read_b64_tr_b16 v[110:111], v6 offset:63744
    s_add_u32 m0, s50, 84928
    s_nop 0
    buffer_load_dwordx4 v13, s[12:15], s54 offen offset:64 lds
    v_mfma_f32_16x16x32_bf16 v[88:91], v[120:123], a[88:91], v[88:91]
    ds_read_b64_tr_b16 v[112:113], v6 offset:64512
    v_mfma_f32_16x16x32_bf16 v[92:95], v[120:123], a[92:95], v[92:95]
    ds_read_b64_tr_b16 v[114:115], v6 offset:64768
    s_add_u32 m0, s50, 86912
    s_nop 0
    buffer_load_dwordx4 v14, s[12:15], s54 offen offset:128 lds
    s_waitcnt lgkmcnt(9)
    v_mfma_f32_16x16x32_bf16 v[64:67], v[96:99], a[96:99], v[64:67]
    v_mfma_f32_16x16x32_bf16 v[68:71], v[96:99], a[100:103], v[68:71]
    s_waitcnt lgkmcnt(7)
    v_mfma_f32_16x16x32_bf16 v[72:75], v[100:103], a[96:99], v[72:75]
    v_mfma_f32_16x16x32_bf16 v[76:79], v[100:103], a[100:103], v[76:79]
    s_waitcnt vmcnt(6) lgkmcnt(0)
    s_barrier
    v_mfma_f32_16x16x32_bf16 v[80:83], v[16:19], a[96:99], v[80:83]
    v_add_u32 v4, 0x15000, v4
    ds_read_b128 a[112:115], v4 offset:0
    v_mfma_f32_16x16x32_bf16 v[84:87], v[16:19], a[100:103], v[84:87]
    ds_read_b128 a[116:119], v4 offset:2048
    v_add_u32 v6, 0x15000, v6
    ds_read_b64_tr_b16 v[96:97], v6 offset:0
    ds_read_b64_tr_b16 v[98:99], v6 offset:256
    ds_read_b64_tr_b16 v[100:101], v6 offset:1024
    ds_read_b64_tr_b16 v[102:103], v6 offset:1280
    s_add_u32 s52, s43, 10
    s_and_b32 s52, s52, 7
    s_mul_i32 s54, s52, 176128
    s_add_u32 m0, s50, 111616
    s_add_u32 s54, s54, s47
    buffer_load_dwordx4 v13, s[12:15], s54 offen offset:0 lds
    v_mfma_f32_16x16x32_bf16 v[64:67], v[108:111], a[104:107], v[64:67]
    ds_read_b128 v[120:123], v12 offset:17280
    v_mfma_f32_16x16x32_bf16 v[68:71], v[108:111], a[108:111], v[68:71]
    v_mfma_f32_16x16x32_bf16 v[72:75], v[112:115], a[104:107], v[72:75]
    v_add_u32 v5, 0x15000, v5
    ds_read_b128 a[120:123], v5 offset:0
    v_mfma_f32_16x16x32_bf16 v[76:79], v[112:115], a[108:111], v[76:79]
    ds_read_b128 a[124:127], v5 offset:2048
    ds_read_b64_tr_b16 v[108:109], v6 offset:6144
    ds_read_b64_tr_b16 v[110:111], v6 offset:6400
    s_add_u32 m0, s50, 113600
    s_nop 0
    buffer_load_dwordx4 v13, s[12:15], s54 offen offset:64 lds
    v_mfma_f32_16x16x32_bf16 v[88:91], v[16:19], a[104:107], v[88:91]
    ds_read_b64_tr_b16 v[112:113], v6 offset:7168
    v_mfma_f32_16x16x32_bf16 v[92:95], v[16:19], a[108:111], v[92:95]
    ds_read_b64_tr_b16 v[114:115], v6 offset:7424
    s_add_u32 m0, s50, 115584
    s_nop 0
    buffer_load_dwordx4 v14, s[12:15], s54 offen offset:128 lds
    s_waitcnt lgkmcnt(9)
    v_mfma_f32_16x16x32_bf16 v[64:67], v[96:99], a[112:115], v[64:67]
    v_mfma_f32_16x16x32_bf16 v[68:71], v[96:99], a[116:119], v[68:71]
    s_waitcnt lgkmcnt(7)
    v_mfma_f32_16x16x32_bf16 v[72:75], v[100:103], a[112:115], v[72:75]
    v_mfma_f32_16x16x32_bf16 v[76:79], v[100:103], a[116:119], v[76:79]
    buffer_load_dword v127, off, s[32:35], 0 sc1
    s_waitcnt vmcnt(7) lgkmcnt(0)
    s_barrier
    v_mfma_f32_16x16x32_bf16 v[80:83], v[120:123], a[112:115], v[80:83]
    ds_read_b64_tr_b16 v[96:97], v2 offset:53248
    v_mfma_f32_16x16x32_bf16 v[84:87], v[120:123], a[116:119], v[84:87]
    ds_read_b64_tr_b16 v[98:99], v2 offset:53504
    ds_read_b64_tr_b16 v[100:101], v2 offset:54272
    ds_read_b64_tr_b16 v[102:103], v2 offset:54528
    s_add_u32 s52, s43, 11
    s_and_b32 s52, s52, 7
    s_mul_i32 s54, s52, 176128
    s_add_u32 m0, s50, 140288
    s_add_u32 s54, s54, s47
    buffer_load_dwordx4 v13, s[12:15], s54 offen offset:0 lds
    v_mfma_f32_16x16x32_bf16 v[64:67], v[108:111], a[120:123], v[64:67]
    ds_read_b64_tr_b16 v[104:105], v2 offset:55296
    v_mfma_f32_16x16x32_bf16 v[68:71], v[108:111], a[124:127], v[68:71]
    ds_read_b64_tr_b16 v[106:107], v2 offset:55552
    v_mfma_f32_16x16x32_bf16 v[72:75], v[112:115], a[120:123], v[72:75]
    ds_read_b64_tr_b16 v[108:109], v2 offset:56320
    v_mfma_f32_16x16x32_bf16 v[76:79], v[112:115], a[124:127], v[76:79]
    ds_read_b64_tr_b16 v[110:111], v2 offset:56576
    s_add_u32 m0, s50, 142272
    s_nop 0
    buffer_load_dwordx4 v13, s[12:15], s54 offen offset:64 lds
    v_mfma_f32_16x16x32_bf16 v[88:91], v[120:123], a[120:123], v[88:91]
    ds_read_b64_tr_b16 v[112:113], v2 offset:57344
    v_mfma_f32_16x16x32_bf16 v[92:95], v[120:123], a[124:127], v[92:95]
    ds_read_b64_tr_b16 v[114:115], v2 offset:57600
    s_add_u32 m0, s50, 144256
    s_nop 0
    buffer_load_dwordx4 v14, s[12:15], s54 offen offset:128 lds
    s_waitcnt lgkmcnt(8)
    v_mfma_f32_16x16x32_bf16 v[16:19], v[96:99], a[0:3], 0
    ds_read_b64_tr_b16 v[116:117], v2 offset:58368
    v_mfma_f32_16x16x32_bf16 v[20:23], v[96:99], a[4:7], 0
    ds_read_b64_tr_b16 v[118:119], v2 offset:58624
    s_waitcnt lgkmcnt(8)
    v_mfma_f32_16x16x32_bf16 v[24:27], v[100:103], a[0:3], 0
    v_add_u32 v2, 0x10000, v2
    ds_read_b64_tr_b16 v[96:97], v2 offset:0
    v_mfma_f32_16x16x32_bf16 v[28:31], v[100:103], a[4:7], 0
    ds_read_b64_tr_b16 v[98:99], v2 offset:256
    s_waitcnt lgkmcnt(8)
    v_mfma_f32_16x16x32_bf16 v[32:35], v[104:107], a[0:3], 0
    ds_read_b64_tr_b16 v[100:101], v2 offset:1024
    v_mfma_f32_16x16x32_bf16 v[36:39], v[104:107], a[4:7], 0
    ds_read_b64_tr_b16 v[102:103], v2 offset:1280
    v_add_f32 v80, v80, v89
    v_add_f32 v81, v84, v93
    s_lshl_b32 s3, s42, 7
    v_lshl_add_u32 v125, v0, 3, s3
    s_mov_b64 exec, 0xffff
    ds_write_b64 v125, v[80:81] offset:18432
    s_mov_b64 exec, -1
    v_cvt_pk_bf16_f32 v72, v72, v73
    s_waitcnt lgkmcnt(9)
    v_mfma_f32_16x16x32_bf16 v[40:43], v[108:111], a[0:3], 0
    ds_read_b64_tr_b16 v[104:105], v2 offset:2048
    v_mfma_f32_16x16x32_bf16 v[44:47], v[108:111], a[4:7], 0
    ds_read_b64_tr_b16 v[106:107], v2 offset:2304
    v_cvt_pk_bf16_f32 v73, v74, v75
    v_cvt_pk_bf16_f32 v74, v76, v77
    v_cvt_pk_bf16_f32 v75, v78, v79
    s_waitcnt lgkmcnt(9)
    v_mfma_f32_16x16x32_bf16 v[48:51], v[112:115], a[0:3], 0
    ds_read_b64_tr_b16 v[108:109], v2 offset:3072
    v_mfma_f32_16x16x32_bf16 v[52:55], v[112:115], a[4:7], 0
    ds_read_b64_tr_b16 v[110:111], v2 offset:3328
    s_sub_u32 s3, 7168, s51
    v_add_u32 v12, s3, v15
    v_permlane16_swap_b32 v72, v74
    v_permlane16_swap_b32 v73, v75
    buffer_store_dwordx4 v[72:75], v15, s[24:27], s56 offen offset:1024 sc1
    s_waitcnt lgkmcnt(9)
    v_mfma_f32_16x16x32_bf16 v[56:59], v[116:119], a[0:3], 0
    ds_read_b64_tr_b16 v[112:113], v2 offset:4096
    v_mfma_f32_16x16x32_bf16 v[60:63], v[116:119], a[4:7], 0
    ds_read_b64_tr_b16 v[114:115], v2 offset:4352
    ds_write_b128 v12, v[72:75]
    v_mov_b32 v84, v126
    v_mov_b32 v85, v126
    v_mov_b32 v86, v126
    v_mov_b32 v87, v126
    v_mul_u32_u24 v125, 1040, v0
    s_mov_b64 exec, 0xffffff
    ds_write_b128 v125, v[84:87] offset:25600
    s_mov_b64 exec, -1
    s_waitcnt lgkmcnt(11)
    v_mfma_f32_16x16x32_bf16 v[16:19], v[96:99], a[8:11], v[16:19]
    ds_read_b64_tr_b16 v[116:117], v2 offset:5120
    v_mfma_f32_16x16x32_bf16 v[20:23], v[96:99], a[12:15], v[20:23]
    ds_read_b64_tr_b16 v[118:119], v2 offset:5376
    s_mov_b32 s4, 0x3eb8aa3b
    s_mov_b32 s5, 0x3eb8aa3b
    v_pk_mul_f32 v[64:65], v[64:65], s[4:5]
    v_pk_mul_f32 v[66:67], v[66:67], s[4:5]
    s_waitcnt lgkmcnt(11)
    v_mfma_f32_16x16x32_bf16 v[24:27], v[100:103], a[8:11], v[24:27]
    v_mfma_f32_16x16x32_bf16 v[28:31], v[100:103], a[12:15], v[28:31]
    s_waitcnt vmcnt(8) lgkmcnt(0)
    s_barrier
    v_mfma_f32_16x16x32_bf16 v[32:35], v[104:107], a[8:11], v[32:35]
    ds_read_b64_tr_b16 v[96:97], v2 offset:16384
    v_mfma_f32_16x16x32_bf16 v[36:39], v[104:107], a[12:15], v[36:39]
    ds_read_b64_tr_b16 v[98:99], v2 offset:16640
    ds_read_b64_tr_b16 v[100:101], v2 offset:17408
    ds_read_b64_tr_b16 v[102:103], v2 offset:17664
    v_pk_mul_f32 v[68:69], v[68:69], s[4:5]
    v_pk_mul_f32 v[70:71], v[70:71], s[4:5]
    v_cvt_pk_bf16_f32 v120, v64, v65
    v_mfma_f32_16x16x32_bf16 v[40:43], v[108:111], a[8:11], v[40:43]
    ds_read_b64_tr_b16 v[104:105], v2 offset:18432
    v_mfma_f32_16x16x32_bf16 v[44:47], v[108:111], a[12:15], v[44:47]
    ds_read_b64_tr_b16 v[106:107], v2 offset:18688
    v_cvt_pk_bf16_f32 v121, v66, v67
    v_cvt_pk_bf16_f32 v122, v68, v69
    v_cvt_pk_bf16_f32 v123, v70, v71
    v_mfma_f32_16x16x32_bf16 v[48:51], v[112:115], a[8:11], v[48:51]
    ds_read_b64_tr_b16 v[108:109], v2 offset:19456
    v_mfma_f32_16x16x32_bf16 v[52:55], v[112:115], a[12:15], v[52:55]
    ds_read_b64_tr_b16 v[110:111], v2 offset:19712
    s_add_u32 s52, s43, 12
    s_and_b32 s52, s52, 7
    s_mul_i32 s54, s52, 176128
    s_add_u32 m0, s50, 54272
    s_add_u32 s54, s54, s47
    buffer_load_dwordx4 v13, s[12:15], s54 offen offset:0 lds
    v_permlane16_swap_b32 v120, v122
    v_permlane16_swap_b32 v121, v123
    v_and_b32 v125, 15, v0
    s_lshl_b32 s3, s42, 7
    v_lshl_add_u32 v125, v125, 3, s3
    ds_read_b64 v[68:69], v125 offset:18432
    ds_read_b128 v[4:7], v15 offset:21504
    v_mfma_f32_16x16x32_bf16 v[56:59], v[116:119], a[8:11], v[56:59]
    ds_read_b64_tr_b16 v[112:113], v2 offset:20480
    v_mfma_f32_16x16x32_bf16 v[60:63], v[116:119], a[12:15], v[60:63]
    ds_read_b64_tr_b16 v[114:115], v2 offset:20736
    s_waitcnt lgkmcnt(10)
    v_mfma_f32_16x16x32_bf16 v[16:19], v[96:99], a[16:19], v[16:19]
    ds_read_b64_tr_b16 v[116:117], v2 offset:21504
    v_mfma_f32_16x16x32_bf16 v[20:23], v[96:99], a[20:23], v[20:23]
    ds_read_b64_tr_b16 v[118:119], v2 offset:21760
    s_waitcnt lgkmcnt(10)
    v_mfma_f32_16x16x32_bf16 v[24:27], v[100:103], a[16:19], v[24:27]
    ds_read_b64_tr_b16 v[96:97], v2 offset:28672
    v_mfma_f32_16x16x32_bf16 v[28:31], v[100:103], a[20:23], v[28:31]
    ds_read_b64_tr_b16 v[98:99], v2 offset:28928
    s_add_u32 m0, s50, 56256
    s_nop 0
    buffer_load_dwordx4 v13, s[12:15], s54 offen offset:64 lds
    s_waitcnt lgkmcnt(10)
    v_mfma_f32_16x16x32_bf16 v[32:35], v[104:107], a[16:19], v[32:35]
    ds_read_b64_tr_b16 v[100:101], v2 offset:29696
    v_mfma_f32_16x16x32_bf16 v[36:39], v[104:107], a[20:23], v[36:39]
    ds_read_b64_tr_b16 v[102:103], v2 offset:29952
    s_waitcnt lgkmcnt(10)
    v_mfma_f32_16x16x32_bf16 v[40:43], v[108:111], a[16:19], v[40:43]
    ds_read_b64_tr_b16 v[104:105], v2 offset:30720
    v_mfma_f32_16x16x32_bf16 v[44:47], v[108:111], a[20:23], v[44:47]
    ds_read_b64_tr_b16 v[106:107], v2 offset:30976
    s_waitcnt lgkmcnt(8)
    v_mfma_f32_16x16x32_bf16 v[48:51], v[112:115], a[16:19], v[48:51]
    ds_read_b64_tr_b16 v[108:109], v2 offset:31744
    v_mfma_f32_16x16x32_bf16 v[52:55], v[112:115], a[20:23], v[52:55]
    ds_read_b64_tr_b16 v[110:111], v2 offset:32000
    s_add_u32 m0, s50, 58240
    s_nop 0
    buffer_load_dwordx4 v14, s[12:15], s54 offen offset:128 lds
    s_waitcnt lgkmcnt(8)
    v_mfma_f32_16x16x32_bf16 v[56:59], v[116:119], a[16:19], v[56:59]
    ds_read_b64_tr_b16 v[112:113], v2 offset:32768
    v_mfma_f32_16x16x32_bf16 v[60:63], v[116:119], a[20:23], v[60:63]
    ds_read_b64_tr_b16 v[114:115], v2 offset:33024
    s_waitcnt lgkmcnt(8)
    v_mfma_f32_16x16x32_bf16 v[16:19], v[96:99], a[24:27], v[16:19]
    ds_read_b64_tr_b16 v[116:117], v2 offset:33792
    v_mfma_f32_16x16x32_bf16 v[20:23], v[96:99], a[28:31], v[20:23]
    ds_read_b64_tr_b16 v[118:119], v2 offset:34048
    s_lshl_b32 s3, s62, 19
    s_add_u32 s62, s62, 1
    s_cmp_eq_u32 s62, 3
    s_cselect_b32 s62, 0, s62
    buffer_load_dword v124, v9, s[16:19], s3 offen
    s_waitcnt lgkmcnt(8)
    v_mfma_f32_16x16x32_bf16 v[24:27], v[100:103], a[24:27], v[24:27]
    v_mfma_f32_16x16x32_bf16 v[28:31], v[100:103], a[28:31], v[28:31]
    s_waitcnt vmcnt(9) lgkmcnt(0)
    s_barrier
    v_mfma_f32_16x16x32_bf16 v[32:35], v[104:107], a[24:27], v[32:35]
    ds_read_b64_tr_b16 v[96:97], v2 offset:45056
    v_mfma_f32_16x16x32_bf16 v[36:39], v[104:107], a[28:31], v[36:39]
    ds_read_b64_tr_b16 v[98:99], v2 offset:45312
    ds_read_b64_tr_b16 v[100:101], v2 offset:46080
    ds_read_b64_tr_b16 v[102:103], v2 offset:46336
    ds_read_b128 v[88:91], v15 offset:19456
    ds_read_b128 v[92:95], v15 offset:20480
    v_mfma_f32_16x16x32_bf16 v[40:43], v[108:111], a[24:27], v[40:43]
    ds_read_b64_tr_b16 v[104:105], v2 offset:47104
    v_mfma_f32_16x16x32_bf16 v[44:47], v[108:111], a[28:31], v[44:47]
    ds_read_b64_tr_b16 v[106:107], v2 offset:47360
    s_mov_b32 s4, 0x3fb8aa3b
    s_mov_b32 s5, 0x3fb8aa3b
    v_pk_mul_f32 v[68:69], v[68:69], s[4:5]
    s_mov_b32 s4, 0xffff0000
    s_mov_b32 s5, 0xffff0000
    v_cndmask_b32_e64 v3, v68, v69, s[4:5]
    v_exp_f32 v68, v68
    v_mfma_f32_16x16x32_bf16 v[48:51], v[112:115], a[24:27], v[48:51]
    ds_read_b64_tr_b16 v[108:109], v2 offset:48128
    v_mfma_f32_16x16x32_bf16 v[52:55], v[112:115], a[28:31], v[52:55]
    ds_read_b64_tr_b16 v[110:111], v2 offset:48384
    s_waitcnt vmcnt(4)
    v_cmp_eq_u32 vcc, 0, v127
    s_cbranch_vccz L_ok_2001
    s_mov_b32 s63, 0x40000
L_spin_2002:
    s_sub_u32 s63, s63, 1
    s_cbranch_scc1 L_ok_2001
    s_sleep 1
    buffer_load_dword v127, off, s[32:35], 0 sc1
    s_waitcnt vmcnt(0)
    v_cmp_eq_u32 vcc, 0, v127
    s_cbranch_vccnz L_spin_2002
L_ok_2001:
    s_mov_b64 exec, 1
    buffer_store_dword v127, off, s[24:27], s0 sc1
    s_mov_b64 exec, -1
    v_exp_f32 v69, v69
    v_exp_f32_e64 v3, -v3
    v_add_f32 v68, 1.0, v68
    v_mfma_f32_16x16x32_bf16 v[56:59], v[116:119], a[24:27], v[56:59]
    ds_read_b64_tr_b16 v[112:113], v2 offset:49152
    v_mfma_f32_16x16x32_bf16 v[60:63], v[116:119], a[28:31], v[60:63]
    ds_read_b64_tr_b16 v[114:115], v2 offset:49408
    v_add_f32 v69, 1.0, v69
    v_add_f32 v3, 1.0, v3
    v_min_f32 v68, 0x7e800000, v68
    s_waitcnt lgkmcnt(10)
    v_mfma_f32_16x16x32_bf16 v[16:19], v[96:99], a[32:35], v[16:19]
    ds_read_b64_tr_b16 v[116:117], v2 offset:50176
    v_mfma_f32_16x16x32_bf16 v[20:23], v[96:99], a[36:39], v[20:23]
    ds_read_b64_tr_b16 v[118:119], v2 offset:50432
    v_min_f32 v69, 0x7e800000, v69
    s_waitcnt lgkmcnt(10)
    v_mfma_f32_16x16x32_bf16 v[24:27], v[100:103], a[32:35], v[24:27]
    ds_read_b64_tr_b16 v[96:97], v2 offset:57344
    v_mfma_f32_16x16x32_bf16 v[28:31], v[100:103], a[36:39], v[28:31]
    ds_read_b64_tr_b16 v[98:99], v2 offset:57600
    s_add_u32 s52, s43, 13
    s_and_b32 s52, s52, 7
    s_mul_i32 s54, s52, 176128
    s_add_u32 m0, s50, 82944
    s_add_u32 s54, s54, s47
    buffer_load_dwordx4 v13, s[12:15], s54 offen offset:0 lds
    v_rcp_f32 v3, v3
    s_waitcnt lgkmcnt(8)
    v_mfma_f32_16x16x32_bf16 v[32:35], v[104:107], a[32:35], v[32:35]
    ds_read_b64_tr_b16 v[100:101], v2 offset:58368
    v_mfma_f32_16x16x32_bf16 v[36:39], v[104:107], a[36:39], v[36:39]
    ds_read_b64_tr_b16 v[102:103], v2 offset:58624
    s_mov_b32 s4, 0xbfb8aa3b
    s_mov_b32 s5, 0xbfb8aa3b
    s_waitcnt lgkmcnt(8)
    v_mfma_f32_16x16x32_bf16 v[40:43], v[108:111], a[32:35], v[40:43]
    ds_read_b64_tr_b16 v[104:105], v2 offset:59392
    v_mfma_f32_16x16x32_bf16 v[44:47], v[108:111], a[36:39], v[44:47]
    ds_read_b64_tr_b16 v[106:107], v2 offset:59648
    s_waitcnt lgkmcnt(8)
    v_mfma_f32_16x16x32_bf16 v[48:51], v[112:115], a[32:35], v[48:51]
    ds_read_b64_tr_b16 v[108:109], v2 offset:60416
    v_mfma_f32_16x16x32_bf16 v[52:55], v[112:115], a[36:39], v[52:55]
    ds_read_b64_tr_b16 v[110:111], v2 offset:60672
    s_add_u32 m0, s50, 84928
    s_nop 0
    buffer_load_dwordx4 v13, s[12:15], s54 offen offset:64 lds
    s_waitcnt lgkmcnt(8)
    v_mfma_f32_16x16x32_bf16 v[56:59], v[116:119], a[32:35], v[56:59]
    ds_read_b64_tr_b16 v[112:113], v2 offset:61440
    v_mfma_f32_16x16x32_bf16 v[60:63], v[116:119], a[36:39], v[60:63]
    ds_read_b64_tr_b16 v[114:115], v2 offset:61696
    s_waitcnt lgkmcnt(8)
    v_mfma_f32_16x16x32_bf16 v[16:19], v[96:99], a[40:43], v[16:19]
    ds_read_b64_tr_b16 v[116:117], v2 offset:62464
    v_mfma_f32_16x16x32_bf16 v[20:23], v[96:99], a[44:47], v[20:23]
    ds_read_b64_tr_b16 v[118:119], v2 offset:62720
    s_lshl_b32 s3, s62, 19
    s_add_u32 s62, s62, 1
    s_cmp_eq_u32 s62, 3
    s_cselect_b32 s62, 0, s62
    buffer_load_dword v67, v9, s[16:19], s3 offen
    s_waitcnt lgkmcnt(8)
    v_mfma_f32_16x16x32_bf16 v[24:27], v[100:103], a[40:43], v[24:27]
    v_mfma_f32_16x16x32_bf16 v[28:31], v[100:103], a[44:47], v[28:31]
    s_add_u32 m0, s50, 86912
    s_nop 0
    buffer_load_dwordx4 v14, s[12:15], s54 offen offset:128 lds
    s_waitcnt lgkmcnt(0)
    s_barrier
    v_mfma_f32_16x16x32_bf16 v[32:35], v[104:107], a[40:43], v[32:35]
    v_add_u32 v2, 0x12000, v2
    ds_read_b64_tr_b16 v[96:97], v2 offset:0
    v_mfma_f32_16x16x32_bf16 v[36:39], v[104:107], a[44:47], v[36:39]
    ds_read_b64_tr_b16 v[98:99], v2 offset:256
    ds_read_b64_tr_b16 v[100:101], v2 offset:1024
    ds_read_b64_tr_b16 v[102:103], v2 offset:1280
    v_add_u32 v4, s51, v4
    v_mfma_f32_16x16x32_bf16 v[40:43], v[108:111], a[40:43], v[40:43]
    ds_read_b64_tr_b16 v[104:105], v2 offset:2048
    v_mfma_f32_16x16x32_bf16 v[44:47], v[108:111], a[44:47], v[44:47]
    ds_read_b64_tr_b16 v[106:107], v2 offset:2304
    s_lshl_b32 s3, s62, 19
    s_add_u32 s62, s62, 1
    s_cmp_eq_u32 s62, 3
    s_cselect_b32 s62, 0, s62
    buffer_load_dword v67, v9, s[16:19], s3 offen
    v_subrev_u32 v5, s61, v5
    v_mfma_f32_16x16x32_bf16 v[48:51], v[112:115], a[40:43], v[48:51]
    ds_read_b64_tr_b16 v[108:109], v2 offset:3072
    v_mfma_f32_16x16x32_bf16 v[52:55], v[112:115], a[44:47], v[52:55]
    ds_read_b64_tr_b16 v[110:111], v2 offset:3328
    s_add_u32 s52, s43, 14
    s_and_b32 s52, s52, 7
    s_mul_i32 s54, s52, 176128
    s_add_u32 m0, s50, 111616
    s_add_u32 s54, s54, s47
    buffer_load_dwordx4 v13, s[12:15], s54 offen offset:0 lds
    s_lshl_b32 s3, s42, 10
    v_add_u32 v6, s3, v6
    v_mfma_f32_16x16x32_bf16 v[56:59], v[116:119], a[40:43], v[56:59]
    ds_read_b64_tr_b16 v[112:113], v2 offset:4096
    v_mfma_f32_16x16x32_bf16 v[60:63], v[116:119], a[44:47], v[60:63]
    ds_read_b64_tr_b16 v[114:115], v2 offset:4352
    s_waitcnt lgkmcnt(8)
    v_mfma_f32_16x16x32_bf16 v[16:19], v[96:99], a[48:51], v[16:19]
    ds_read_b64_tr_b16 v[116:117], v2 offset:5120
    v_mfma_f32_16x16x32_bf16 v[20:23], v[96:99], a[52:55], v[20:23]
    ds_read_b64_tr_b16 v[118:119], v2 offset:5376
    s_waitcnt lgkmcnt(8)
    v_mfma_f32_16x16x32_bf16 v[24:27], v[100:103], a[48:51], v[24:27]
    ds_read_b64_tr_b16 v[96:97], v2 offset:12288
    v_mfma_f32_16x16x32_bf16 v[28:31], v[100:103], a[52:55], v[28:31]
    ds_read_b64_tr_b16 v[98:99], v2 offset:12544
    s_add_u32 m0, s50, 113600
    s_nop 0
    buffer_load_dwordx4 v13, s[12:15], s54 offen offset:64 lds
    s_waitcnt lgkmcnt(8)
    v_mfma_f32_16x16x32_bf16 v[32:35], v[104:107], a[48:51], v[32:35]
    ds_read_b64_tr_b16 v[100:101], v2 offset:13312
    v_mfma_f32_16x16x32_bf16 v[36:39], v[104:107], a[52:55], v[36:39]
    ds_read_b64_tr_b16 v[102:103], v2 offset:13568
    s_waitcnt lgkmcnt(8)
    v_mfma_f32_16x16x32_bf16 v[40:43], v[108:111], a[48:51], v[40:43]
    ds_read_b64_tr_b16 v[104:105], v2 offset:14336
    v_mfma_f32_16x16x32_bf16 v[44:47], v[108:111], a[52:55], v[44:47]
    ds_read_b64_tr_b16 v[106:107], v2 offset:14592
    s_waitcnt lgkmcnt(8)
    v_mfma_f32_16x16x32_bf16 v[48:51], v[112:115], a[48:51], v[48:51]
    ds_read_b64_tr_b16 v[108:109], v2 offset:15360
    v_mfma_f32_16x16x32_bf16 v[52:55], v[112:115], a[52:55], v[52:55]
    ds_read_b64_tr_b16 v[110:111], v2 offset:15616
    s_add_u32 m0, s50, 115584
    s_nop 0
    buffer_load_dwordx4 v14, s[12:15], s54 offen offset:128 lds
    s_waitcnt lgkmcnt(8)
    v_mfma_f32_16x16x32_bf16 v[56:59], v[116:119], a[48:51], v[56:59]
    ds_read_b64_tr_b16 v[112:113], v2 offset:16384
    v_mfma_f32_16x16x32_bf16 v[60:63], v[116:119], a[52:55], v[60:63]
    ds_read_b64_tr_b16 v[114:115], v2 offset:16640
    s_waitcnt lgkmcnt(8)
    v_mfma_f32_16x16x32_bf16 v[16:19], v[96:99], a[56:59], v[16:19]
    ds_read_b64_tr_b16 v[116:117], v2 offset:17408
    v_mfma_f32_16x16x32_bf16 v[20:23], v[96:99], a[60:63], v[20:23]
    ds_read_b64_tr_b16 v[118:119], v2 offset:17664
    s_waitcnt lgkmcnt(8)
    v_mfma_f32_16x16x32_bf16 v[24:27], v[100:103], a[56:59], v[24:27]
    v_mfma_f32_16x16x32_bf16 v[28:31], v[100:103], a[60:63], v[28:31]
    s_waitcnt vmcnt(10) lgkmcnt(0)
    s_barrier
    v_mfma_f32_16x16x32_bf16 v[32:35], v[104:107], a[56:59], v[32:35]
    v_add_u32 v2, 0xfffeb000, v2
    ds_read_b64_tr_b16 v[96:97], v2 offset:0
    v_mfma_f32_16x16x32_bf16 v[36:39], v[104:107], a[60:63], v[36:39]
    ds_read_b64_tr_b16 v[98:99], v2 offset:256
    ds_read_b64_tr_b16 v[100:101], v2 offset:1024
    ds_read_b64_tr_b16 v[102:103], v2 offset:1280
    v_mfma_f32_16x16x32_bf16 v[40:43], v[108:111], a[56:59], v[40:43]
    ds_read_b64_tr_b16 v[104:105], v2 offset:2048
    v_mfma_f32_16x16x32_bf16 v[44:47], v[108:111], a[60:63], v[44:47]
    ds_read_b64_tr_b16 v[106:107], v2 offset:2304
    s_mov_b32 s3, 0
    buffer_load_dword v67, v9, s[20:23], s3 offen
    v_mfma_f32_16x16x32_bf16 v[48:51], v[112:115], a[56:59], v[48:51]
    ds_read_b64_tr_b16 v[108:109], v2 offset:3072
    v_mfma_f32_16x16x32_bf16 v[52:55], v[112:115], a[60:63], v[52:55]
    ds_read_b64_tr_b16 v[110:111], v2 offset:3328
    v_and_b32 v125, 1, v0
    v_lshlrev_b32 v125, 6, v125
    buffer_load_dword v124, v125, s[24:27], s96 offen sc1
    s_add_u32 s52, s43, 15
    s_and_b32 s52, s52, 7
    s_mul_i32 s54, s52, 176128
    s_add_u32 m0, s50, 140288
    s_add_u32 s54, s54, s47
    buffer_load_dwordx4 v13, s[12:15], s54 offen offset:0 lds
    v_mfma_f32_16x16x32_bf16 v[56:59], v[116:119], a[56:59], v[56:59]
    ds_read_b64_tr_b16 v[112:113], v2 offset:4096
    v_mfma_f32_16x16x32_bf16 v[60:63], v[116:119], a[60:63], v[60:63]
    ds_read_b64_tr_b16 v[114:115], v2 offset:4352
    s_waitcnt lgkmcnt(8)
    v_mfma_f32_16x16x32_bf16 v[16:19], v[96:99], a[64:67], v[16:19]
    ds_read_b64_tr_b16 v[116:117], v2 offset:5120
    v_mfma_f32_16x16x32_bf16 v[20:23], v[96:99], a[68:71], v[20:23]
    ds_read_b64_tr_b16 v[118:119], v2 offset:5376
    s_waitcnt lgkmcnt(8)
    v_mfma_f32_16x16x32_bf16 v[24:27], v[100:103], a[64:67], v[24:27]
    ds_read_b64_tr_b16 v[96:97], v2 offset:12288
    v_mfma_f32_16x16x32_bf16 v[28:31], v[100:103], a[68:71], v[28:31]
    ds_read_b64_tr_b16 v[98:99], v2 offset:12544
    s_add_u32 m0, s50, 142272
    s_nop 0
    buffer_load_dwordx4 v13, s[12:15], s54 offen offset:64 lds
    s_waitcnt lgkmcnt(8)
    v_mfma_f32_16x16x32_bf16 v[32:35], v[104:107], a[64:67], v[32:35]
    ds_read_b64_tr_b16 v[100:101], v2 offset:13312
    v_mfma_f32_16x16x32_bf16 v[36:39], v[104:107], a[68:71], v[36:39]
    ds_read_b64_tr_b16 v[102:103], v2 offset:13568
    s_waitcnt lgkmcnt(8)
    v_mfma_f32_16x16x32_bf16 v[40:43], v[108:111], a[64:67], v[40:43]
    ds_read_b64_tr_b16 v[104:105], v2 offset:14336
    v_mfma_f32_16x16x32_bf16 v[44:47], v[108:111], a[68:71], v[44:47]
    ds_read_b64_tr_b16 v[106:107], v2 offset:14592
    s_waitcnt lgkmcnt(8)
    v_mfma_f32_16x16x32_bf16 v[48:51], v[112:115], a[64:67], v[48:51]
    ds_read_b64_tr_b16 v[108:109], v2 offset:15360
    v_mfma_f32_16x16x32_bf16 v[52:55], v[112:115], a[68:71], v[52:55]
    ds_read_b64_tr_b16 v[110:111], v2 offset:15616
    s_add_u32 m0, s50, 144256
    s_nop 0
    buffer_load_dwordx4 v14, s[12:15], s54 offen offset:128 lds
    s_waitcnt lgkmcnt(8)
    v_mfma_f32_16x16x32_bf16 v[56:59], v[116:119], a[64:67], v[56:59]
    ds_read_b64_tr_b16 v[112:113], v2 offset:16384
    v_mfma_f32_16x16x32_bf16 v[60:63], v[116:119], a[68:71], v[60:63]
    ds_read_b64_tr_b16 v[114:115], v2 offset:16640
    s_waitcnt lgkmcnt(8)
    v_mfma_f32_16x16x32_bf16 v[16:19], v[96:99], a[72:75], v[16:19]
    ds_read_b64_tr_b16 v[116:117], v2 offset:17408
    v_mfma_f32_16x16x32_bf16 v[20:23], v[96:99], a[76:79], v[20:23]
    ds_read_b64_tr_b16 v[118:119], v2 offset:17664
    s_waitcnt lgkmcnt(8)
    v_mfma_f32_16x16x32_bf16 v[24:27], v[100:103], a[72:75], v[24:27]
    v_mfma_f32_16x16x32_bf16 v[28:31], v[100:103], a[76:79], v[28:31]
    v_add_u32 v13, 0x2000, v8
    s_add_u32 s3, s97, 0x1000
    v_add_u32 v14, s3, v15
    s_waitcnt vmcnt(9) lgkmcnt(0)
    s_barrier
    v_mfma_f32_16x16x32_bf16 v[32:35], v[104:107], a[72:75], v[32:35]
    ds_read_b64_tr_b16 v[96:97], v2 offset:28672
    v_mfma_f32_16x16x32_bf16 v[36:39], v[104:107], a[76:79], v[36:39]
    ds_read_b64_tr_b16 v[98:99], v2 offset:28928
    ds_read_b64_tr_b16 v[100:101], v2 offset:29696
    ds_read_b64_tr_b16 v[102:103], v2 offset:29952
    v_mfma_f32_16x16x32_bf16 v[40:43], v[108:111], a[72:75], v[40:43]
    ds_read_b64_tr_b16 v[104:105], v2 offset:30720
    v_mfma_f32_16x16x32_bf16 v[44:47], v[108:111], a[76:79], v[44:47]
    ds_read_b64_tr_b16 v[106:107], v2 offset:30976
    v_mfma_f32_16x16x32_bf16 v[48:51], v[112:115], a[72:75], v[48:51]
    ds_read_b64_tr_b16 v[108:109], v2 offset:31744
    v_mfma_f32_16x16x32_bf16 v[52:55], v[112:115], a[76:79], v[52:55]
    ds_read_b64_tr_b16 v[110:111], v2 offset:32000
    s_add_u32 m0, s51, 57856
    s_add_u32 s39, s36, 0
    buffer_load_dwordx4 v8, s[16:19], s39 offen lds
    v_mfma_f32_16x16x32_bf16 v[56:59], v[116:119], a[72:75], v[56:59]
    ds_read_b64_tr_b16 v[112:113], v2 offset:32768
    v_mfma_f32_16x16x32_bf16 v[60:63], v[116:119], a[76:79], v[60:63]
    ds_read_b64_tr_b16 v[114:115], v2 offset:33024
    s_waitcnt lgkmcnt(8)
    v_mfma_f32_16x16x32_bf16 v[16:19], v[96:99], a[80:83], v[16:19]
    ds_read_b64_tr_b16 v[116:117], v2 offset:33792
    v_mfma_f32_16x16x32_bf16 v[20:23], v[96:99], a[84:87], v[20:23]
    ds_read_b64_tr_b16 v[118:119], v2 offset:34048
    s_waitcnt lgkmcnt(8)
    v_mfma_f32_16x16x32_bf16 v[24:27], v[100:103], a[80:83], v[24:27]
    ds_read_b64_tr_b16 v[96:97], v2 offset:40960
    v_mfma_f32_16x16x32_bf16 v[28:31], v[100:103], a[84:87], v[28:31]
    ds_read_b64_tr_b16 v[98:99], v2 offset:41216
    s_add_u32 m0, s51, 58880
    s_nop 0
    buffer_load_dwordx4 v13, s[16:19], s39 offen lds
    s_waitcnt lgkmcnt(8)
    v_mfma_f32_16x16x32_bf16 v[32:35], v[104:107], a[80:83], v[32:35]
    ds_read_b64_tr_b16 v[100:101], v2 offset:41984
    v_mfma_f32_16x16x32_bf16 v[36:39], v[104:107], a[84:87], v[36:39]
    ds_read_b64_tr_b16 v[102:103], v2 offset:42240
    s_waitcnt lgkmcnt(8)
    v_mfma_f32_16x16x32_bf16 v[40:43], v[108:111], a[80:83], v[40:43]
    ds_read_b64_tr_b16 v[104:105], v2 offset:43008
    v_mfma_f32_16x16x32_bf16 v[44:47], v[108:111], a[84:87], v[44:47]
    ds_read_b64_tr_b16 v[106:107], v2 offset:43264
    s_waitcnt lgkmcnt(8)
    v_mfma_f32_16x16x32_bf16 v[48:51], v[112:115], a[80:83], v[48:51]
    ds_read_b64_tr_b16 v[108:109], v2 offset:44032
    v_mfma_f32_16x16x32_bf16 v[52:55], v[112:115], a[84:87], v[52:55]
    ds_read_b64_tr_b16 v[110:111], v2 offset:44288
    s_waitcnt vmcnt(5)
    v_cmp_ne_u32 vcc, v127, v124
    s_cbranch_vccz L_ok_2003
    s_mov_b32 s63, 0x40000
L_spin_2004:
    s_sub_u32 s63, s63, 1
    s_cbranch_scc1 L_ok_2003
    s_sleep 1
    buffer_load_dword v124, v125, s[24:27], s96 offen sc1
    s_waitcnt vmcnt(0)
    v_cmp_ne_u32 vcc, v127, v124
    s_cbranch_vccnz L_spin_2004
L_ok_2003:
    s_sub_u32 m0, 14336, s51
    v_and_b32 v72, s98, v15
    buffer_load_dwordx4 v72, s[24:27], s99 offen offset:0 sc1 lds
    buffer_load_dwordx4 v72, s[24:27], s99 offen offset:1024 sc1 lds
    s_waitcnt lgkmcnt(8)
    v_mfma_f32_16x16x32_bf16 v[56:59], v[116:119], a[80:83], v[56:59]
    ds_read_b64_tr_b16 v[112:113], v2 offset:45056
    v_mfma_f32_16x16x32_bf16 v[60:63], v[116:119], a[84:87], v[60:63]
    ds_read_b64_tr_b16 v[114:115], v2 offset:45312
    s_waitcnt lgkmcnt(8)
    v_mfma_f32_16x16x32_bf16 v[16:19], v[96:99], a[88:91], v[16:19]
    ds_read_b64_tr_b16 v[116:117], v2 offset:46080
    v_mfma_f32_16x16x32_bf16 v[20:23], v[96:99], a[92:95], v[20:23]
    ds_read_b64_tr_b16 v[118:119], v2 offset:46336
    s_waitcnt lgkmcnt(8)
    v_mfma_f32_16x16x32_bf16 v[24:27], v[100:103], a[88:91], v[24:27]
    v_mfma_f32_16x16x32_bf16 v[28:31], v[100:103], a[92:95], v[28:31]
    s_sub_u32 m0, 37088, s61
    v_add_u32 v73, s40, v15
    buffer_load_dwordx4 v73, s[24:27], s99 offen offset:2048 sc1 lds
    s_sub_u32 m0, 37104, s61
    s_nop 0
    buffer_load_dwordx4 v73, s[24:27], s99 offen offset:3072 sc1 lds
    s_waitcnt lgkmcnt(0)
    s_barrier
    v_mfma_f32_16x16x32_bf16 v[32:35], v[104:107], a[88:91], v[32:35]
    ds_read_b64_tr_b16 v[96:97], v2 offset:57344
    v_mfma_f32_16x16x32_bf16 v[36:39], v[104:107], a[92:95], v[36:39]
    ds_read_b64_tr_b16 v[98:99], v2 offset:57600
    ds_read_b64_tr_b16 v[100:101], v2 offset:58368
    ds_read_b64_tr_b16 v[102:103], v2 offset:58624
    v_mfma_f32_16x16x32_bf16 v[40:43], v[108:111], a[88:91], v[40:43]
    ds_read_b64_tr_b16 v[104:105], v2 offset:59392
    v_mfma_f32_16x16x32_bf16 v[44:47], v[108:111], a[92:95], v[44:47]
    ds_read_b64_tr_b16 v[106:107], v2 offset:59648
    v_mfma_f32_16x16x32_bf16 v[48:51], v[112:115], a[88:91], v[48:51]
    ds_read_b64_tr_b16 v[108:109], v2 offset:60416
    v_mfma_f32_16x16x32_bf16 v[52:55], v[112:115], a[92:95], v[52:55]
    ds_read_b64_tr_b16 v[110:111], v2 offset:60672
    s_add_u32 m0, s51, 74240
    s_add_u32 s39, s36, 16384
    buffer_load_dwordx4 v8, s[16:19], s39 offen lds
    v_mfma_f32_16x16x32_bf16 v[56:59], v[116:119], a[88:91], v[56:59]
    ds_read_b64_tr_b16 v[112:113], v2 offset:61440
    v_mfma_f32_16x16x32_bf16 v[60:63], v[116:119], a[92:95], v[60:63]
    ds_read_b64_tr_b16 v[114:115], v2 offset:61696
    s_waitcnt lgkmcnt(8)
    v_mfma_f32_16x16x32_bf16 v[16:19], v[96:99], a[96:99], v[16:19]
    ds_read_b64_tr_b16 v[116:117], v2 offset:62464
    v_mfma_f32_16x16x32_bf16 v[20:23], v[96:99], a[100:103], v[20:23]
    ds_read_b64_tr_b16 v[118:119], v2 offset:62720
    s_waitcnt lgkmcnt(8)
    v_mfma_f32_16x16x32_bf16 v[24:27], v[100:103], a[96:99], v[24:27]
    v_add_u32 v2, 0x11000, v2
    ds_read_b64_tr_b16 v[96:97], v2 offset:0
    v_mfma_f32_16x16x32_bf16 v[28:31], v[100:103], a[100:103], v[28:31]
    ds_read_b64_tr_b16 v[98:99], v2 offset:256
    s_add_u32 m0, s51, 75264
    s_nop 0
    buffer_load_dwordx4 v13, s[16:19], s39 offen lds
    s_waitcnt lgkmcnt(8)
    v_mfma_f32_16x16x32_bf16 v[32:35], v[104:107], a[96:99], v[32:35]
    ds_read_b64_tr_b16 v[100:101], v2 offset:1024
    v_mfma_f32_16x16x32_bf16 v[36:39], v[104:107], a[100:103], v[36:39]
    ds_read_b64_tr_b16 v[102:103], v2 offset:1280
    s_waitcnt lgkmcnt(8)
    v_mfma_f32_16x16x32_bf16 v[40:43], v[108:111], a[96:99], v[40:43]
    ds_read_b64_tr_b16 v[104:105], v2 offset:2048
    v_mfma_f32_16x16x32_bf16 v[44:47], v[108:111], a[100:103], v[44:47]
    ds_read_b64_tr_b16 v[106:107], v2 offset:2304
    s_waitcnt lgkmcnt(8)
    v_mfma_f32_16x16x32_bf16 v[48:51], v[112:115], a[96:99], v[48:51]
    ds_read_b64_tr_b16 v[108:109], v2 offset:3072
    v_mfma_f32_16x16x32_bf16 v[52:55], v[112:115], a[100:103], v[52:55]
    ds_read_b64_tr_b16 v[110:111], v2 offset:3328
    s_add_u32 m0, s51, 90624
    s_add_u32 s39, s36, 32768
    buffer_load_dwordx4 v8, s[16:19], s39 offen lds
    s_waitcnt lgkmcnt(8)
    v_mfma_f32_16x16x32_bf16 v[56:59], v[116:119], a[96:99], v[56:59]
    ds_read_b64_tr_b16 v[112:113], v2 offset:4096
    v_mfma_f32_16x16x32_bf16 v[60:63], v[116:119], a[100:103], v[60:63]
    ds_read_b64_tr_b16 v[114:115], v2 offset:4352
    s_waitcnt lgkmcnt(8)
    v_mfma_f32_16x16x32_bf16 v[16:19], v[96:99], a[104:107], v[16:19]
    ds_read_b64_tr_b16 v[116:117], v2 offset:5120
    v_mfma_f32_16x16x32_bf16 v[20:23], v[96:99], a[108:111], v[20:23]
    ds_read_b64_tr_b16 v[118:119], v2 offset:5376
    s_waitcnt lgkmcnt(8)
    v_mfma_f32_16x16x32_bf16 v[24:27], v[100:103], a[104:107], v[24:27]
    v_mfma_f32_16x16x32_bf16 v[28:31], v[100:103], a[108:111], v[28:31]
    s_add_u32 m0, s51, 91648
    s_nop 0
    buffer_load_dwordx4 v13, s[16:19], s39 offen lds
    s_waitcnt vmcnt(10) lgkmcnt(0)
    s_barrier
    s_setprio 2
    v_mfma_f32_16x16x32_bf16 v[32:35], v[104:107], a[104:107], v[32:35]
    ds_read_b64_tr_b16 v[96:97], v2 offset:16384
    v_mfma_f32_16x16x32_bf16 v[36:39], v[104:107], a[108:111], v[36:39]
    ds_read_b64_tr_b16 v[98:99], v2 offset:16640
    ds_read_b64_tr_b16 v[100:101], v2 offset:17408
    ds_read_b64_tr_b16 v[102:103], v2 offset:17664
    v_mfma_f32_16x16x32_bf16 v[40:43], v[108:111], a[104:107], v[40:43]
    ds_read_b64_tr_b16 v[104:105], v2 offset:18432
    v_mfma_f32_16x16x32_bf16 v[44:47], v[108:111], a[108:111], v[44:47]
    ds_read_b64_tr_b16 v[106:107], v2 offset:18688
    v_mfma_f32_16x16x32_bf16 v[48:51], v[112:115], a[104:107], v[48:51]
    ds_read_b64_tr_b16 v[108:109], v2 offset:19456
    v_mfma_f32_16x16x32_bf16 v[52:55], v[112:115], a[108:111], v[52:55]
    ds_read_b64_tr_b16 v[110:111], v2 offset:19712
    s_add_u32 m0, s51, 107008
    s_add_u32 s39, s36, 49152
    buffer_load_dwordx4 v8, s[16:19], s39 offen lds
    v_mfma_f32_16x16x32_bf16 v[56:59], v[116:119], a[104:107], v[56:59]
    ds_read_b64_tr_b16 v[112:113], v2 offset:20480
    v_mfma_f32_16x16x32_bf16 v[60:63], v[116:119], a[108:111], v[60:63]
    ds_read_b64_tr_b16 v[114:115], v2 offset:20736
    s_waitcnt lgkmcnt(8)
    v_mfma_f32_16x16x32_bf16 v[16:19], v[96:99], a[112:115], v[16:19]
    ds_read_b64_tr_b16 v[116:117], v2 offset:21504
    v_mfma_f32_16x16x32_bf16 v[20:23], v[96:99], a[116:119], v[20:23]
    ds_read_b64_tr_b16 v[118:119], v2 offset:21760
    s_waitcnt lgkmcnt(8)
    v_mfma_f32_16x16x32_bf16 v[24:27], v[100:103], a[112:115], v[24:27]
    ds_read_b64_tr_b16 v[96:97], v2 offset:28672
    v_mfma_f32_16x16x32_bf16 v[28:31], v[100:103], a[116:119], v[28:31]
    ds_read_b64_tr_b16 v[98:99], v2 offset:28928
    s_add_u32 m0, s51, 108032
    s_nop 0
    buffer_load_dwordx4 v13, s[16:19], s39 offen lds
    s_waitcnt lgkmcnt(8)
    v_mfma_f32_16x16x32_bf16 v[32:35], v[104:107], a[112:115], v[32:35]
    ds_read_b64_tr_b16 v[100:101], v2 offset:29696
    v_mfma_f32_16x16x32_bf16 v[36:39], v[104:107], a[116:119], v[36:39]
    ds_read_b64_tr_b16 v[102:103], v2 offset:29952
    s_waitcnt lgkmcnt(8)
    v_mfma_f32_16x16x32_bf16 v[40:43], v[108:111], a[112:115], v[40:43]
    ds_read_b64_tr_b16 v[104:105], v2 offset:30720
    v_mfma_f32_16x16x32_bf16 v[44:47], v[108:111], a[116:119], v[44:47]
    ds_read_b64_tr_b16 v[106:107], v2 offset:30976
    s_waitcnt lgkmcnt(8)
    v_mfma_f32_16x16x32_bf16 v[48:51], v[112:115], a[112:115], v[48:51]
    ds_read_b64_tr_b16 v[108:109], v2 offset:31744
    v_mfma_f32_16x16x32_bf16 v[52:55], v[112:115], a[116:119], v[52:55]
    ds_read_b64_tr_b16 v[110:111], v2 offset:32000
    s_add_u32 m0, s51, 123392
    s_add_u32 s39, s36, 65536
    buffer_load_dwordx4 v8, s[16:19], s39 offen lds
    s_waitcnt lgkmcnt(8)
    v_mfma_f32_16x16x32_bf16 v[56:59], v[116:119], a[112:115], v[56:59]
    ds_read_b64_tr_b16 v[112:113], v2 offset:32768
    v_mfma_f32_16x16x32_bf16 v[60:63], v[116:119], a[116:119], v[60:63]
    ds_read_b64_tr_b16 v[114:115], v2 offset:33024
    s_waitcnt lgkmcnt(8)
    v_mfma_f32_16x16x32_bf16 v[16:19], v[96:99], a[120:123], v[16:19]
    ds_read_b64_tr_b16 v[116:117], v2 offset:33792
    v_mfma_f32_16x16x32_bf16 v[20:23], v[96:99], a[124:127], v[20:23]
    ds_read_b64_tr_b16 v[118:119], v2 offset:34048
    s_waitcnt lgkmcnt(8)
    v_mfma_f32_16x16x32_bf16 v[24:27], v[100:103], a[120:123], v[24:27]
    v_mfma_f32_16x16x32_bf16 v[28:31], v[100:103], a[124:127], v[28:31]
    s_add_u32 m0, s51, 124416
    s_nop 0
    buffer_load_dwordx4 v13, s[16:19], s39 offen lds
    s_waitcnt vmcnt(8) lgkmcnt(0)
    s_barrier
    v_mfma_f32_16x16x32_bf16 v[32:35], v[104:107], a[120:123], v[32:35]
    v_mfma_f32_16x16x32_bf16 v[36:39], v[104:107], a[124:127], v[36:39]
    v_mfma_f32_16x16x32_bf16 v[40:43], v[108:111], a[120:123], v[40:43]
    v_mfma_f32_16x16x32_bf16 v[44:47], v[108:111], a[124:127], v[44:47]
    v_mfma_f32_16x16x32_bf16 v[48:51], v[112:115], a[120:123], v[48:51]
    v_mfma_f32_16x16x32_bf16 v[52:55], v[112:115], a[124:127], v[52:55]
    s_add_u32 m0, s51, 139776
    s_add_u32 s39, s36, 81920
    buffer_load_dwordx4 v8, s[16:19], s39 offen lds
    v_mfma_f32_16x16x32_bf16 v[56:59], v[116:119], a[120:123], v[56:59]
    v_mfma_f32_16x16x32_bf16 v[60:63], v[116:119], a[124:127], v[60:63]
    s_add_u32 m0, s51, 140800
    s_nop 0
    buffer_load_dwordx4 v13, s[16:19], s39 offen lds
    v_xor_b32 v2, 64, v4
    s_setprio 3
    v_pk_mul_f32 v[16:17], v[16:17], s[4:5]
    v_pk_mul_f32 v[18:19], v[18:19], s[4:5]
    v_pk_mul_f32 v[20:21], v[20:21], s[4:5]
    v_pk_mul_f32 v[22:23], v[22:23], s[4:5]
    v_exp_f32 v16, v16
    v_exp_f32 v17, v17
    v_exp_f32 v18, v18
    v_exp_f32 v19, v19
    v_exp_f32 v20, v20
    v_exp_f32 v21, v21
    v_exp_f32 v22, v22
    v_exp_f32 v23, v23
    v_pk_fma_f32 v[16:17], v[16:17], v[68:69], v[68:69] op_sel_hi:[1,0,0]
    v_pk_fma_f32 v[18:19], v[18:19], v[68:69], v[68:69] op_sel_hi:[1,0,0]
    v_pk_fma_f32 v[20:21], v[20:21], v[68:69], v[68:69] op_sel:[0,1,1] op_sel_hi:[1,1,1]
    v_pk_fma_f32 v[22:23], v[22:23], v[68:69], v[68:69] op_sel:[0,1,1] op_sel_hi:[1,1,1]
    v_rcp_f32 v16, v16
    v_rcp_f32 v17, v17
    v_rcp_f32 v18, v18
    v_rcp_f32 v19, v19
    v_rcp_f32 v20, v20
    v_rcp_f32 v21, v21
    v_rcp_f32 v22, v22
    v_rcp_f32 v23, v23
    v_pk_mul_f32 v[16:17], v[16:17], v[24:25]
    v_pk_mul_f32 v[18:19], v[18:19], v[26:27]
    v_pk_mul_f32 v[20:21], v[20:21], v[28:29]
    v_pk_mul_f32 v[22:23], v[22:23], v[30:31]
    v_cvt_pk_bf16_f32 v96, v16, v17
    v_cvt_pk_bf16_f32 v98, v20, v21
    v_cvt_pk_bf16_f32 v97, v18, v19
    v_cvt_pk_bf16_f32 v99, v22, v23
    v_permlane16_swap_b32 v96, v98
    s_nop 0
    v_permlane16_swap_b32 v97, v99
    buffer_store_dwordx4 v[96:99], v15, s[24:27], s57 offen offset:0 sc1
    v_pk_mul_f32 v[32:33], v[32:33], s[4:5]
    v_pk_mul_f32 v[34:35], v[34:35], s[4:5]
    v_pk_mul_f32 v[36:37], v[36:37], s[4:5]
    v_pk_mul_f32 v[38:39], v[38:39], s[4:5]
    v_exp_f32 v32, v32
    v_exp_f32 v33, v33
    v_exp_f32 v34, v34
    v_exp_f32 v35, v35
    v_exp_f32 v36, v36
    v_exp_f32 v37, v37
    v_exp_f32 v38, v38
    v_exp_f32 v39, v39
    v_pk_fma_f32 v[32:33], v[32:33], v[68:69], v[68:69] op_sel_hi:[1,0,0]
    v_pk_fma_f32 v[34:35], v[34:35], v[68:69], v[68:69] op_sel_hi:[1,0,0]
    v_pk_fma_f32 v[36:37], v[36:37], v[68:69], v[68:69] op_sel:[0,1,1] op_sel_hi:[1,1,1]
    v_pk_fma_f32 v[38:39], v[38:39], v[68:69], v[68:69] op_sel:[0,1,1] op_sel_hi:[1,1,1]
    v_rcp_f32 v32, v32
    v_rcp_f32 v33, v33
    v_rcp_f32 v34, v34
    v_rcp_f32 v35, v35
    v_rcp_f32 v36, v36
    v_rcp_f32 v37, v37
    v_rcp_f32 v38, v38
    v_rcp_f32 v39, v39
    v_pk_mul_f32 v[32:33], v[32:33], v[40:41]
    v_pk_mul_f32 v[34:35], v[34:35], v[42:43]
    v_pk_mul_f32 v[36:37], v[36:37], v[44:45]
    v_pk_mul_f32 v[38:39], v[38:39], v[46:47]
    v_cvt_pk_bf16_f32 v100, v32, v33
    v_cvt_pk_bf16_f32 v102, v36, v37
    v_cvt_pk_bf16_f32 v101, v34, v35
    v_cvt_pk_bf16_f32 v103, v38, v39
    v_permlane16_swap_b32 v100, v102
    s_nop 0
    v_permlane16_swap_b32 v101, v103
    buffer_store_dwordx4 v[100:103], v15, s[24:27], s57 offen offset:2048 sc1
    v_pk_mul_f32 v[48:49], v[48:49], s[4:5]
    v_pk_mul_f32 v[50:51], v[50:51], s[4:5]
    v_pk_mul_f32 v[52:53], v[52:53], s[4:5]
    v_pk_mul_f32 v[54:55], v[54:55], s[4:5]
    v_exp_f32 v48, v48
    v_exp_f32 v49, v49
    v_exp_f32 v50, v50
    v_exp_f32 v51, v51
    v_exp_f32 v52, v52
    v_exp_f32 v53, v53
    v_exp_f32 v54, v54
    v_exp_f32 v55, v55
    v_pk_fma_f32 v[48:49], v[48:49], v[68:69], v[68:69] op_sel_hi:[1,0,0]
    v_pk_fma_f32 v[50:51], v[50:51], v[68:69], v[68:69] op_sel_hi:[1,0,0]
    v_pk_fma_f32 v[52:53], v[52:53], v[68:69], v[68:69] op_sel:[0,1,1] op_sel_hi:[1,1,1]
    v_pk_fma_f32 v[54:55], v[54:55], v[68:69], v[68:69] op_sel:[0,1,1] op_sel_hi:[1,1,1]
    v_rcp_f32 v48, v48
    v_rcp_f32 v49, v49
    v_rcp_f32 v50, v50
    v_rcp_f32 v51, v51
    v_rcp_f32 v52, v52
    v_rcp_f32 v53, v53
    v_rcp_f32 v54, v54
    v_rcp_f32 v55, v55
    v_pk_mul_f32 v[48:49], v[48:49], v[56:57]
    v_pk_mul_f32 v[50:51], v[50:51], v[58:59]
    v_pk_mul_f32 v[52:53], v[52:53], v[60:61]
    v_pk_mul_f32 v[54:55], v[54:55], v[62:63]
    v_cvt_pk_bf16_f32 v104, v48, v49
    v_cvt_pk_bf16_f32 v106, v52, v53
    v_cvt_pk_bf16_f32 v105, v50, v51
    v_cvt_pk_bf16_f32 v107, v54, v55
    v_permlane16_swap_b32 v104, v106
    s_nop 0
    v_permlane16_swap_b32 v105, v107
    buffer_store_dwordx4 v[104:107], v14, s[24:27], s57 offen sc1
    v_mov_b32 v126, 0x7e800000
    ds_read_b128 a[0:3], v12 offset:16384
    ds_read_b128 a[4:7], v12 offset:0
    ds_read_b128 a[8:11], v12 offset:14336
    ds_read_b64_tr_b16 a[28:29], v4 offset:57856
    ds_read_b64_tr_b16 a[30:31], v4 offset:58880
    ds_read_b64_tr_b16 a[32:33], v2 offset:57856
    ds_read_b64_tr_b16 a[34:35], v2 offset:58880
    s_waitcnt vmcnt(11)
    v_add_u32 v4, 0x12200, v4
    ds_read_b64_tr_b16 a[36:37], v4 offset:0
    ds_read_b64_tr_b16 a[38:39], v4 offset:1024
    v_add_u32 v2, 0x12200, v2
    ds_read_b64_tr_b16 a[40:41], v2 offset:0
    ds_read_b64_tr_b16 a[42:43], v2 offset:1024
    s_waitcnt vmcnt(9)
    ds_read_b64_tr_b16 a[44:45], v4 offset:16384
    ds_read_b64_tr_b16 a[46:47], v4 offset:17408
    ds_read_b64_tr_b16 a[48:49], v2 offset:16384
    ds_read_b64_tr_b16 a[50:51], v2 offset:17408
    s_waitcnt vmcnt(7)
    ds_read_b64_tr_b16 a[52:53], v4 offset:32768
    ds_read_b64_tr_b16 a[54:55], v4 offset:33792
    ds_read_b64_tr_b16 a[56:57], v2 offset:32768
    ds_read_b64_tr_b16 a[58:59], v2 offset:33792
    s_waitcnt vmcnt(5)
    ds_read_b64_tr_b16 a[60:61], v4 offset:49152
    ds_read_b64_tr_b16 a[62:63], v4 offset:50176
    ds_read_b64_tr_b16 a[64:65], v2 offset:49152
    ds_read_b64_tr_b16 a[66:67], v2 offset:50176
    s_waitcnt lgkmcnt(15)
    s_add_u32 m0, s51, 57856
    s_add_u32 s39, s36, 98304
    buffer_load_dwordx4 v8, s[16:19], s39 offen lds
    s_add_u32 m0, s51, 58880
    s_nop 0
    buffer_load_dwordx4 v13, s[16:19], s39 offen lds
    s_waitcnt lgkmcnt(12)
    s_add_u32 m0, s51, 74240
    s_add_u32 s39, s36, 114688
    buffer_load_dwordx4 v8, s[16:19], s39 offen lds
    s_add_u32 m0, s51, 75264
    s_nop 0
    buffer_load_dwordx4 v13, s[16:19], s39 offen lds
    s_waitcnt lgkmcnt(8)
    s_add_u32 m0, s51, 90624
    s_add_u32 s39, s60, 0
    buffer_load_dwordx4 v8, s[20:23], s39 offen lds
    s_add_u32 m0, s51, 91648
    s_nop 0
    buffer_load_dwordx4 v13, s[20:23], s39 offen lds
    s_waitcnt lgkmcnt(4)
    s_add_u32 m0, s51, 107008
    s_add_u32 s39, s60, 16384
    buffer_load_dwordx4 v8, s[20:23], s39 offen lds
    s_add_u32 m0, s51, 108032
    s_nop 0
    buffer_load_dwordx4 v13, s[20:23], s39 offen lds
    s_waitcnt lgkmcnt(0)
    s_add_u32 m0, s51, 123392
    s_add_u32 s39, s60, 32768
    buffer_load_dwordx4 v8, s[20:23], s39 offen lds
    s_add_u32 m0, s51, 124416
    s_nop 0
    buffer_load_dwordx4 v13, s[20:23], s39 offen lds
    s_waitcnt vmcnt(10)
    s_mov_b64 exec, 1
    buffer_store_dword v127, off, s[24:27], s1 sc1
    s_mov_b64 exec, -1
    s_setprio 1
    v_add_u32 v4, 0x10000, v4
    ds_read_b64_tr_b16 a[68:69], v4 offset:0
    ds_read_b64_tr_b16 a[70:71], v4 offset:1024
    v_add_u32 v2, 0x10000, v2
    ds_read_b64_tr_b16 a[72:73], v2 offset:0
    ds_read_b64_tr_b16 a[74:75], v2 offset:1024
    s_waitcnt lgkmcnt(0)
    s_add_u32 m0, s51, 139776
    s_add_u32 s39, s60, 49152
    buffer_load_dwordx4 v8, s[20:23], s39 offen lds
    s_add_u32 m0, s51, 140800
    s_nop 0
    buffer_load_dwordx4 v13, s[20:23], s39 offen lds
    s_waitcnt vmcnt(11)
    v_add_u32 v4, 0xfffec000, v4
    ds_read_b64_tr_b16 a[76:77], v4 offset:0
    ds_read_b64_tr_b16 a[78:79], v4 offset:1024
    v_add_u32 v2, 0xfffec000, v2
    ds_read_b64_tr_b16 a[80:81], v2 offset:0
    ds_read_b64_tr_b16 a[82:83], v2 offset:1024
    s_waitcnt lgkmcnt(0)
    s_add_u32 m0, s51, 57856
    s_add_u32 s39, s60, 65536
    buffer_load_dwordx4 v8, s[20:23], s39 offen lds
    s_add_u32 m0, s51, 58880
    s_nop 0
    buffer_load_dwordx4 v13, s[20:23], s39 offen lds
    s_waitcnt vmcnt(11)
    ds_read_b64_tr_b16 a[84:85], v4 offset:16384
    ds_read_b64_tr_b16 a[86:87], v4 offset:17408
    ds_read_b64_tr_b16 a[88:89], v2 offset:16384
    ds_read_b64_tr_b16 a[90:91], v2 offset:17408
    s_waitcnt lgkmcnt(0)
    s_add_u32 m0, s51, 74240
    s_add_u32 s39, s60, 81920
    buffer_load_dwordx4 v8, s[20:23], s39 offen lds
    s_add_u32 m0, s51, 75264
    s_nop 0
    buffer_load_dwordx4 v13, s[20:23], s39 offen lds
    s_waitcnt vmcnt(11)
    ds_read_b64_tr_b16 a[92:93], v4 offset:32768
    ds_read_b64_tr_b16 a[94:95], v4 offset:33792
    ds_read_b64_tr_b16 a[96:97], v2 offset:32768
    ds_read_b64_tr_b16 a[98:99], v2 offset:33792
    s_waitcnt lgkmcnt(0)
    s_add_u32 m0, s51, 90624
    s_add_u32 s39, s60, 98304
    buffer_load_dwordx4 v8, s[20:23], s39 offen lds
    s_add_u32 m0, s51, 91648
    s_nop 0
    buffer_load_dwordx4 v13, s[20:23], s39 offen lds
    s_waitcnt vmcnt(11)
    ds_read_b64_tr_b16 a[100:101], v4 offset:49152
    ds_read_b64_tr_b16 a[102:103], v4 offset:50176
    ds_read_b64_tr_b16 a[104:105], v2 offset:49152
    ds_read_b64_tr_b16 a[106:107], v2 offset:50176
    s_waitcnt lgkmcnt(0)
    s_add_u32 m0, s51, 107008
    s_add_u32 s39, s60, 114688
    buffer_load_dwordx4 v8, s[20:23], s39 offen lds
    s_add_u32 m0, s51, 108032
    s_nop 0
    buffer_load_dwordx4 v13, s[20:23], s39 offen lds
    s_waitcnt vmcnt(11)
    v_add_u32 v4, 0x10000, v4
    ds_read_b64_tr_b16 a[108:109], v4 offset:0
    ds_read_b64_tr_b16 a[110:111], v4 offset:1024
    v_add_u32 v2, 0x10000, v2
    ds_read_b64_tr_b16 a[112:113], v2 offset:0
    ds_read_b64_tr_b16 a[114:115], v2 offset:1024
    s_waitcnt vmcnt(8)
    ds_read_b64_tr_b16 a[116:117], v4 offset:16384
    ds_read_b64_tr_b16 a[118:119], v4 offset:17408
    ds_read_b64_tr_b16 a[120:121], v2 offset:16384
    ds_read_b64_tr_b16 a[122:123], v2 offset:17408
    v_mfma_f32_32x32x16_bf16 v[16:31], a[0:3], v[120:123], 0
    ds_read_b128 a[0:3], v12 offset:12288
    v_mfma_f32_32x32x16_bf16 v[32:47], a[4:7], v[120:123], 0
    ds_read_b128 a[4:7], v12 offset:10240
    ds_read_b128 a[12:15], v5 offset:16640
    ds_read_b128 a[16:19], v5 offset:17680
    ds_read_b128 a[20:23], v5 offset:0
    ds_read_b128 a[24:27], v5 offset:1040
    s_nop 6
    v_cndmask_b32_e64 v16, v16, v32, s[64:65]
    v_cndmask_b32_e64 v17, v17, v33, s[66:67]
    v_cndmask_b32_e64 v18, v18, v34, s[68:69]
    v_cndmask_b32_e64 v19, v19, v35, s[70:71]
    v_cndmask_b32_e64 v20, v20, v36, s[72:73]
    v_cndmask_b32_e64 v21, v21, v37, s[74:75]
    v_cndmask_b32_e64 v22, v22, v38, s[76:77]
    v_cndmask_b32_e64 v23, v23, v39, s[78:79]
    v_cndmask_b32_e64 v24, v24, v40, s[80:81]
    v_cndmask_b32_e64 v25, v25, v41, s[82:83]
    v_cndmask_b32_e64 v26, v26, v42, s[84:85]
    v_cndmask_b32_e64 v27, v27, v43, s[86:87]
    v_cndmask_b32_e64 v28, v28, v44, s[88:89]
    v_cndmask_b32_e64 v29, v29, v45, s[90:91]
    v_cndmask_b32_e64 v30, v30, v46, s[92:93]
    v_cndmask_b32_e64 v31, v31, v47, s[94:95]
    v_mfma_f32_32x32x16_bf16 v[32:47], a[8:11], v[120:123], 0
    ds_read_b128 a[8:11], v12 offset:8192
    v_exp_f32 v16, v16
    v_exp_f32 v17, v17
    v_exp_f32 v18, v18
    v_exp_f32 v19, v19
    v_exp_f32 v20, v20
    v_exp_f32 v21, v21
    v_exp_f32 v22, v22
    v_exp_f32 v23, v23
    v_exp_f32 v24, v24
    v_exp_f32 v25, v25
    v_exp_f32 v26, v26
    v_exp_f32 v27, v27
    v_exp_f32 v28, v28
    v_exp_f32 v29, v29
    v_exp_f32 v30, v30
    v_exp_f32 v31, v31
    v_cvt_pk_bf16_f32 v96, v16, v17
    v_cvt_pk_bf16_f32 v97, v18, v19
    v_cvt_pk_bf16_f32 v98, v20, v21
    v_cvt_pk_bf16_f32 v99, v22, v23
    v_cvt_pk_bf16_f32 v100, v24, v25
    v_cvt_pk_bf16_f32 v101, v26, v27
    v_cvt_pk_bf16_f32 v102, v28, v29
    v_cvt_pk_bf16_f32 v103, v30, v31
    s_waitcnt lgkmcnt(6)
    v_mfma_f32_32x32x16_bf16 v[16:31], a[0:3], v[120:123], 0
    ds_read_b128 a[0:3], v12 offset:6144
    v_and_b32 v104, v96, v88
    v_and_b32 v105, v97, v89
    v_and_b32 v106, v98, v90
    v_and_b32 v107, v99, v91
    v_and_b32 v108, v100, v92
    v_and_b32 v109, v101, v93
    v_and_b32 v110, v102, v94
    v_and_b32 v111, v103, v95
    v_xor_b32 v96, v96, v104
    v_xor_b32 v97, v97, v105
    v_xor_b32 v98, v98, v106
    v_xor_b32 v99, v99, v107
    v_xor_b32 v100, v100, v108
    v_xor_b32 v101, v101, v109
    v_xor_b32 v102, v102, v110
    v_xor_b32 v103, v103, v111
    s_waitcnt lgkmcnt(3)
    v_mfma_f32_32x32x16_bf16 v[64:79], a[20:23], v[104:107], 0
    s_waitcnt lgkmcnt(2)
    v_mfma_f32_32x32x16_bf16 v[64:79], a[24:27], v[108:111], v[64:79]
    v_mfma_f32_32x32x16_bf16 v[64:79], a[12:15], v[96:99], v[64:79]
    v_mfma_f32_32x32x16_bf16 v[64:79], a[16:19], v[100:103], v[64:79]
    ds_read_b128 a[20:23], v5 offset:14560
    ds_read_b128 a[24:27], v5 offset:15600
    ds_read_b128 a[12:15], v5 offset:12480
    ds_read_b128 a[16:19], v5 offset:13520
    v_exp_f32 v32, v32
    v_exp_f32 v33, v33
    v_exp_f32 v34, v34
    v_exp_f32 v35, v35
    v_exp_f32 v36, v36
    v_exp_f32 v37, v37
    v_exp_f32 v38, v38
    v_exp_f32 v39, v39
    v_exp_f32 v40, v40
    v_exp_f32 v41, v41
    v_exp_f32 v42, v42
    v_exp_f32 v43, v43
    v_exp_f32 v44, v44
    v_exp_f32 v45, v45
    v_exp_f32 v46, v46
    v_exp_f32 v47, v47
    v_cvt_pk_bf16_f32 v104, v32, v33
    v_cvt_pk_bf16_f32 v105, v34, v35
    v_cvt_pk_bf16_f32 v106, v36, v37
    v_cvt_pk_bf16_f32 v107, v38, v39
    v_cvt_pk_bf16_f32 v108, v40, v41
    v_cvt_pk_bf16_f32 v109, v42, v43
    v_cvt_pk_bf16_f32 v110, v44, v45
    v_cvt_pk_bf16_f32 v111, v46, v47
    v_mfma_f32_32x32x16_bf16 v[32:47], a[4:7], v[120:123], 0
    ds_read_b128 a[4:7], v12 offset:4096
    s_waitcnt lgkmcnt(4)
    v_mfma_f32_32x32x16_bf16 v[64:79], a[20:23], v[104:107], v[64:79]
    s_waitcnt lgkmcnt(3)
    v_mfma_f32_32x32x16_bf16 v[64:79], a[24:27], v[108:111], v[64:79]
    ds_read_b128 a[20:23], v5 offset:10400
    ds_read_b128 a[24:27], v5 offset:11440
    v_exp_f32 v16, v16
    v_exp_f32 v17, v17
    v_exp_f32 v18, v18
    v_exp_f32 v19, v19
    v_exp_f32 v20, v20
    v_exp_f32 v21, v21
    v_exp_f32 v22, v22
    v_exp_f32 v23, v23
    v_exp_f32 v24, v24
    v_exp_f32 v25, v25
    v_exp_f32 v26, v26
    v_exp_f32 v27, v27
    v_exp_f32 v28, v28
    v_exp_f32 v29, v29
    v_exp_f32 v30, v30
    v_exp_f32 v31, v31
    v_cvt_pk_bf16_f32 v96, v16, v17
    v_cvt_pk_bf16_f32 v97, v18, v19
    v_cvt_pk_bf16_f32 v98, v20, v21
    v_cvt_pk_bf16_f32 v99, v22, v23
    v_cvt_pk_bf16_f32 v100, v24, v25
    v_cvt_pk_bf16_f32 v101, v26, v27
    v_cvt_pk_bf16_f32 v102, v28, v29
    v_cvt_pk_bf16_f32 v103, v30, v31
    v_mfma_f32_32x32x16_bf16 v[16:31], a[8:11], v[120:123], 0
    ds_read_b128 a[8:11], v12 offset:2048
    s_waitcnt lgkmcnt(5)
    v_mfma_f32_32x32x16_bf16 v[64:79], a[12:15], v[96:99], v[64:79]
    s_waitcnt lgkmcnt(4)
    v_mfma_f32_32x32x16_bf16 v[64:79], a[16:19], v[100:103], v[64:79]
    ds_read_b128 a[12:15], v5 offset:8320
    ds_read_b128 a[16:19], v5 offset:9360
    v_exp_f32 v32, v32
    v_exp_f32 v33, v33
    v_exp_f32 v34, v34
    v_exp_f32 v35, v35
    v_exp_f32 v36, v36
    v_exp_f32 v37, v37
    v_exp_f32 v38, v38
    v_exp_f32 v39, v39
    v_exp_f32 v40, v40
    v_exp_f32 v41, v41
    v_exp_f32 v42, v42
    v_exp_f32 v43, v43
    v_exp_f32 v44, v44
    v_exp_f32 v45, v45
    v_exp_f32 v46, v46
    v_exp_f32 v47, v47
    v_cvt_pk_bf16_f32 v104, v32, v33
    v_cvt_pk_bf16_f32 v105, v34, v35
    v_cvt_pk_bf16_f32 v106, v36, v37
    v_cvt_pk_bf16_f32 v107, v38, v39
    v_cvt_pk_bf16_f32 v108, v40, v41
    v_cvt_pk_bf16_f32 v109, v42, v43
    v_cvt_pk_bf16_f32 v110, v44, v45
    v_cvt_pk_bf16_f32 v111, v46, v47
    v_mfma_f32_32x32x16_bf16 v[32:47], a[0:3], v[120:123], 0
    s_waitcnt lgkmcnt(4)
    v_mfma_f32_32x32x16_bf16 v[64:79], a[20:23], v[104:107], v[64:79]
    s_waitcnt lgkmcnt(3)
    v_mfma_f32_32x32x16_bf16 v[64:79], a[24:27], v[108:111], v[64:79]
    ds_read_b128 a[20:23], v5 offset:6240
    ds_read_b128 a[24:27], v5 offset:7280
    v_exp_f32 v16, v16
    v_exp_f32 v17, v17
    v_exp_f32 v18, v18
    v_exp_f32 v19, v19
    v_exp_f32 v20, v20
    v_exp_f32 v21, v21
    v_exp_f32 v22, v22
    v_exp_f32 v23, v23
    v_exp_f32 v24, v24
    v_exp_f32 v25, v25
    v_exp_f32 v26, v26
    v_exp_f32 v27, v27
    v_exp_f32 v28, v28
    v_exp_f32 v29, v29
    v_exp_f32 v30, v30
    v_exp_f32 v31, v31
    v_cvt_pk_bf16_f32 v96, v16, v17
    v_cvt_pk_bf16_f32 v97, v18, v19
    v_cvt_pk_bf16_f32 v98, v20, v21
    v_cvt_pk_bf16_f32 v99, v22, v23
    v_cvt_pk_bf16_f32 v100, v24, v25
    v_cvt_pk_bf16_f32 v101, v26, v27
    v_cvt_pk_bf16_f32 v102, v28, v29
    v_cvt_pk_bf16_f32 v103, v30, v31
    v_mfma_f32_32x32x16_bf16 v[16:31], a[4:7], v[120:123], 0
    s_waitcnt lgkmcnt(3)
    v_mfma_f32_32x32x16_bf16 v[64:79], a[12:15], v[96:99], v[64:79]
    s_waitcnt lgkmcnt(2)
    v_mfma_f32_32x32x16_bf16 v[64:79], a[16:19], v[100:103], v[64:79]
    ds_read_b128 a[12:15], v5 offset:4160
    ds_read_b128 a[16:19], v5 offset:5200
    v_exp_f32 v32, v32
    v_exp_f32 v33, v33
    v_exp_f32 v34, v34
    v_exp_f32 v35, v35
    v_exp_f32 v36, v36
    v_exp_f32 v37, v37
    v_exp_f32 v38, v38
    v_exp_f32 v39, v39
    v_exp_f32 v40, v40
    v_exp_f32 v41, v41
    v_exp_f32 v42, v42
    v_exp_f32 v43, v43
    v_exp_f32 v44, v44
    v_exp_f32 v45, v45
    v_exp_f32 v46, v46
    v_exp_f32 v47, v47
    v_cvt_pk_bf16_f32 v104, v32, v33
    v_cvt_pk_bf16_f32 v105, v34, v35
    v_cvt_pk_bf16_f32 v106, v36, v37
    v_cvt_pk_bf16_f32 v107, v38, v39
    v_cvt_pk_bf16_f32 v108, v40, v41
    v_cvt_pk_bf16_f32 v109, v42, v43
    v_cvt_pk_bf16_f32 v110, v44, v45
    v_cvt_pk_bf16_f32 v111, v46, v47
    v_mfma_f32_32x32x16_bf16 v[32:47], a[8:11], v[120:123], 0
    s_waitcnt lgkmcnt(3)
    v_mfma_f32_32x32x16_bf16 v[64:79], a[20:23], v[104:107], v[64:79]
    s_waitcnt lgkmcnt(2)
    v_mfma_f32_32x32x16_bf16 v[64:79], a[24:27], v[108:111], v[64:79]
    ds_read_b128 a[20:23], v5 offset:2080
    ds_read_b128 a[24:27], v5 offset:3120
    v_exp_f32 v16, v16
    v_exp_f32 v17, v17
    v_exp_f32 v18, v18
    v_exp_f32 v19, v19
    v_exp_f32 v20, v20
    v_exp_f32 v21, v21
    v_exp_f32 v22, v22
    v_exp_f32 v23, v23
    v_exp_f32 v24, v24
    v_exp_f32 v25, v25
    v_exp_f32 v26, v26
    v_exp_f32 v27, v27
    v_exp_f32 v28, v28
    v_exp_f32 v29, v29
    v_exp_f32 v30, v30
    v_exp_f32 v31, v31
    v_cvt_pk_bf16_f32 v96, v16, v17
    v_cvt_pk_bf16_f32 v97, v18, v19
    v_cvt_pk_bf16_f32 v98, v20, v21
    v_cvt_pk_bf16_f32 v99, v22, v23
    v_cvt_pk_bf16_f32 v100, v24, v25
    v_cvt_pk_bf16_f32 v101, v26, v27
    v_cvt_pk_bf16_f32 v102, v28, v29
    v_cvt_pk_bf16_f32 v103, v30, v31
    s_waitcnt lgkmcnt(3)
    v_mfma_f32_32x32x16_bf16 v[64:79], a[12:15], v[96:99], v[64:79]
    s_waitcnt lgkmcnt(2)
    v_mfma_f32_32x32x16_bf16 v[64:79], a[16:19], v[100:103], v[64:79]
    buffer_load_dword v124, v10, s[24:27], s58 offen sc1
    v_exp_f32 v32, v32
    v_exp_f32 v33, v33
    v_exp_f32 v34, v34
    v_exp_f32 v35, v35
    v_exp_f32 v36, v36
    v_exp_f32 v37, v37
    v_exp_f32 v38, v38
    v_exp_f32 v39, v39
    v_exp_f32 v40, v40
    v_exp_f32 v41, v41
    v_exp_f32 v42, v42
    v_exp_f32 v43, v43
    v_exp_f32 v44, v44
    v_exp_f32 v45, v45
    v_exp_f32 v46, v46
    v_exp_f32 v47, v47
    v_cvt_pk_bf16_f32 v104, v32, v33
    v_cvt_pk_bf16_f32 v105, v34, v35
    v_cvt_pk_bf16_f32 v106, v36, v37
    v_cvt_pk_bf16_f32 v107, v38, v39
    v_cvt_pk_bf16_f32 v108, v40, v41
    v_cvt_pk_bf16_f32 v109, v42, v43
    v_cvt_pk_bf16_f32 v110, v44, v45
    v_cvt_pk_bf16_f32 v111, v46, v47
    s_waitcnt lgkmcnt(1)
    v_mfma_f32_32x32x16_bf16 v[64:79], a[20:23], v[104:107], v[64:79]
    s_waitcnt lgkmcnt(0)
    v_mfma_f32_32x32x16_bf16 v[64:79], a[24:27], v[108:111], v[64:79]
    v_mov_b32 v80, 0x35800000
    v_mov_b32 v81, 0x4b800000
    s_nop 9
    v_add_f32_e64 v82, |v64|, |v65|
    v_add_f32_e64 v83, |v66|, |v67|
    v_add_f32_e64 v84, |v68|, |v69|
    v_add_f32_e64 v85, |v70|, |v71|
    v_med3_f32 v80, v72, v80, v81
    v_pk_add_f32 v[82:83], v[82:83], v[84:85]
    v_cmp_neq_f32_e64 s[4:5], v80, v72
    v_add_f32 v82, v82, v83
    v_cmp_nlt_f32 vcc, v82, v126
    s_nop 0
    s_or_b64 vcc, vcc, s[4:5]
    s_cbranch_scc1 L_slow_2005
L_back_2006:
    v_rcp_f32 v72, v72
    v_add_u32 v14, 120832, v15
    v_mul_f32 v72, v72, v3
    v_pk_mul_f32 v[64:65], v[64:65], v[72:73] op_sel_hi:[1,0]
    v_pk_mul_f32 v[66:67], v[66:67], v[72:73] op_sel_hi:[1,0]
    v_pk_mul_f32 v[68:69], v[68:69], v[72:73] op_sel_hi:[1,0]
    v_pk_mul_f32 v[70:71], v[70:71], v[72:73] op_sel_hi:[1,0]
    v_cvt_pk_bf16_f32 v120, v64, v65
    v_cvt_pk_bf16_f32 v121, v66, v67
    v_cvt_pk_bf16_f32 v122, v68, v69
    v_cvt_pk_bf16_f32 v123, v70, v71
    buffer_store_dwordx4 v[120:123], v15, s[24:27], s41 offen sc1
    s_waitcnt vmcnt(1)
    v_cmp_ne_u32 vcc, v127, v124
    s_cbranch_vccz L_ok_2007
    s_mov_b32 s63, 0x40000
L_spin_2008:
    s_sub_u32 s63, s63, 1
    s_cbranch_scc1 L_ok_2007
    s_sleep 1
    buffer_load_dword v124, v10, s[24:27], s58 offen sc1
    s_waitcnt vmcnt(0)
    v_cmp_ne_u32 vcc, v127, v124
    s_cbranch_vccnz L_spin_2008
L_ok_2007:
    v_add_u32 v4, 0xffff0000, v4
    ds_read_b64_tr_b16 a[0:1], v4 offset:0
    ds_read_b64_tr_b16 a[2:3], v4 offset:1024
    v_add_u32 v2, 0xffff0000, v2
    ds_read_b64_tr_b16 a[4:5], v2 offset:0
    ds_read_b64_tr_b16 a[6:7], v2 offset:1024
    ds_read_b64_tr_b16 a[8:9], v4 offset:16384
    ds_read_b64_tr_b16 a[10:11], v4 offset:17408
    ds_read_b64_tr_b16 a[12:13], v2 offset:16384
    ds_read_b64_tr_b16 a[14:15], v2 offset:17408
    ds_read_b64_tr_b16 a[16:17], v4 offset:32768
    ds_read_b64_tr_b16 a[18:19], v4 offset:33792
    ds_read_b64_tr_b16 a[20:21], v2 offset:32768
    ds_read_b64_tr_b16 a[22:23], v2 offset:33792
    s_add_u32 s3, s1, 262144
    s_waitcnt vmcnt(0)
    s_mov_b64 exec, 1
    buffer_store_dword v127, off, s[24:27], s3 sc1
    s_mov_b64 exec, -1
    buffer_load_dwordx4 v[80:83], v15, s[24:27], s37 offen offset:0 sc1
    buffer_load_dwordx4 v[84:87], v14, s[24:27], s37 offen offset:0 sc1
    buffer_load_dwordx4 v[88:91], v15, s[24:27], s37 offen offset:1024 sc1
    buffer_load_dwordx4 v[92:95], v14, s[24:27], s37 offen offset:1024 sc1
    buffer_load_dwordx4 v[96:99], v15, s[24:27], s37 offen offset:2048 sc1
    buffer_load_dwordx4 v[100:103], v14, s[24:27], s37 offen offset:2048 sc1
    buffer_load_dwordx4 v[104:107], v15, s[24:27], s37 offen offset:3072 sc1
    buffer_load_dwordx4 v[108:111], v14, s[24:27], s37 offen offset:3072 sc1
    s_add_u32 s37, s37, 0x1000
    buffer_load_dwordx4 v[112:115], v15, s[24:27], s37 offen offset:0 sc1
    buffer_load_dwordx4 v[116:119], v14, s[24:27], s37 offen offset:0 sc1
    s_waitcnt vmcnt(9)
    v_mfma_f32_32x32x16_bf16 v[16:31], v[80:83], a[28:31], 0
    v_mfma_f32_32x32x16_bf16 v[32:47], v[80:83], a[32:35], 0
    s_waitcnt vmcnt(8)
    v_mfma_f32_32x32x16_bf16 v[48:63], v[84:87], a[28:31], 0
    v_mfma_f32_32x32x16_bf16 v[64:79], v[84:87], a[32:35], 0
    buffer_load_dwordx4 a[28:31], v15, s[24:27], s37 offen offset:1024 sc1
    buffer_load_dwordx4 a[32:35], v14, s[24:27], s37 offen offset:1024 sc1
    s_waitcnt vmcnt(9)
    v_mfma_f32_32x32x16_bf16 v[16:31], v[88:91], a[36:39], v[16:31]
    v_mfma_f32_32x32x16_bf16 v[32:47], v[88:91], a[40:43], v[32:47]
    s_waitcnt vmcnt(8)
    v_mfma_f32_32x32x16_bf16 v[48:63], v[92:95], a[36:39], v[48:63]
    v_mfma_f32_32x32x16_bf16 v[64:79], v[92:95], a[40:43], v[64:79]
    s_cmp_eq_u32 s42, 3
    s_cselect_b32 s3, 0x1000, 0
    s_sub_u32 s37, s37, s3
    buffer_load_dwordx4 a[36:39], v15, s[24:27], s37 offen offset:2048 sc1
    buffer_load_dwordx4 a[40:43], v14, s[24:27], s37 offen offset:2048 sc1
    buffer_load_dword v124, v11, s[24:27], s58 offen sc1
    s_waitcnt vmcnt(10)
    v_mfma_f32_32x32x16_bf16 v[16:31], v[96:99], a[44:47], v[16:31]
    v_mfma_f32_32x32x16_bf16 v[32:47], v[96:99], a[48:51], v[32:47]
    s_waitcnt vmcnt(9)
    v_mfma_f32_32x32x16_bf16 v[48:63], v[100:103], a[44:47], v[48:63]
    v_mfma_f32_32x32x16_bf16 v[64:79], v[100:103], a[48:51], v[64:79]
    buffer_load_dwordx4 a[44:47], v15, s[24:27], s37 offen offset:3072 sc1
    buffer_load_dwordx4 a[48:51], v14, s[24:27], s37 offen offset:3072 sc1
    s_waitcnt vmcnt(10)
    v_mfma_f32_32x32x16_bf16 v[16:31], v[104:107], a[52:55], v[16:31]
    v_mfma_f32_32x32x16_bf16 v[32:47], v[104:107], a[56:59], v[32:47]
    s_waitcnt vmcnt(9)
    v_mfma_f32_32x32x16_bf16 v[48:63], v[108:111], a[52:55], v[48:63]
    v_mfma_f32_32x32x16_bf16 v[64:79], v[108:111], a[56:59], v[64:79]
    s_waitcnt vmcnt(2)
    v_cmp_ne_u32 vcc, v127, v124
    s_cbranch_vccz L_ok_2009
    s_mov_b32 s63, 0x40000
L_spin_2010:
    s_sub_u32 s63, s63, 1
    s_cbranch_scc1 L_ok_2009
    s_sleep 1
    buffer_load_dword v124, v11, s[24:27], s58 offen sc1
    s_waitcnt vmcnt(0)
    v_cmp_ne_u32 vcc, v127, v124
    s_cbranch_vccnz L_spin_2010
L_ok_2009:
    buffer_load_dwordx4 a[52:55], v15, s[24:27], s38 offen offset:0 sc1
    buffer_load_dwordx4 a[56:59], v14, s[24:27], s38 offen offset:0 sc1
    v_mfma_f32_32x32x16_bf16 v[16:31], v[112:115], a[60:63], v[16:31]
    v_mfma_f32_32x32x16_bf16 v[32:47], v[112:115], a[64:67], v[32:47]
    v_mfma_f32_32x32x16_bf16 v[48:63], v[116:119], a[60:63], v[48:63]
    v_mfma_f32_32x32x16_bf16 v[64:79], v[116:119], a[64:67], v[64:79]
    buffer_load_dwordx4 a[60:63], v15, s[24:27], s38 offen offset:1024 sc1
    buffer_load_dwordx4 a[64:67], v14, s[24:27], s38 offen offset:1024 sc1
    v_mfma_f32_32x32x16_bf16 v[16:31], a[28:31], a[68:71], v[16:31]
    v_mfma_f32_32x32x16_bf16 v[32:47], a[28:31], a[72:75], v[32:47]
    v_mfma_f32_32x32x16_bf16 v[48:63], a[32:35], a[68:71], v[48:63]
    v_mfma_f32_32x32x16_bf16 v[64:79], a[32:35], a[72:75], v[64:79]
    buffer_load_dwordx4 a[68:71], v15, s[24:27], s38 offen offset:2048 sc1
    buffer_load_dwordx4 a[72:75], v14, s[24:27], s38 offen offset:2048 sc1
    s_waitcnt lgkmcnt(0)
    s_barrier
    v_mfma_f32_32x32x16_bf16 v[16:31], a[36:39], a[76:79], v[16:31]
    v_mfma_f32_32x32x16_bf16 v[32:47], a[36:39], a[80:83], v[32:47]
    v_mfma_f32_32x32x16_bf16 v[48:63], a[40:43], a[76:79], v[48:63]
    v_mfma_f32_32x32x16_bf16 v[64:79], a[40:43], a[80:83], v[64:79]
    buffer_load_dwordx4 a[76:79], v15, s[24:27], s38 offen offset:3072 sc1
    buffer_load_dwordx4 a[80:83], v14, s[24:27], s38 offen offset:3072 sc1
    s_waitcnt vmcnt(9)
    v_mfma_f32_32x32x16_bf16 v[16:31], a[44:47], a[84:87], v[16:31]
    v_mfma_f32_32x32x16_bf16 v[32:47], a[44:47], a[88:91], v[32:47]
    s_waitcnt vmcnt(8)
    v_mfma_f32_32x32x16_bf16 v[48:63], a[48:51], a[84:87], v[48:63]
    v_mfma_f32_32x32x16_bf16 v[64:79], a[48:51], a[88:91], v[64:79]
    s_add_u32 s38, s38, 0x1000
    buffer_load_dwordx4 a[84:87], v15, s[24:27], s38 offen offset:0 sc1
    buffer_load_dwordx4 a[88:91], v14, s[24:27], s38 offen offset:0 sc1
    s_waitcnt vmcnt(9)
    v_mfma_f32_32x32x16_bf16 v[16:31], a[52:55], a[92:95], v[16:31]
    v_mfma_f32_32x32x16_bf16 v[32:47], a[52:55], a[96:99], v[32:47]
    s_waitcnt vmcnt(8)
    v_mfma_f32_32x32x16_bf16 v[48:63], a[56:59], a[92:95], v[48:63]
    v_mfma_f32_32x32x16_bf16 v[64:79], a[56:59], a[96:99], v[64:79]
    buffer_load_dwordx4 a[92:95], v15, s[24:27], s38 offen offset:1024 sc1
    buffer_load_dwordx4 a[96:99], v14, s[24:27], s38 offen offset:1024 sc1
    s_waitcnt vmcnt(9)
    v_mfma_f32_32x32x16_bf16 v[16:31], a[60:63], a[100:103], v[16:31]
    v_mfma_f32_32x32x16_bf16 v[32:47], a[60:63], a[104:107], v[32:47]
    s_waitcnt vmcnt(8)
    v_mfma_f32_32x32x16_bf16 v[48:63], a[64:67], a[100:103], v[48:63]
    v_mfma_f32_32x32x16_bf16 v[64:79], a[64:67], a[104:107], v[64:79]
    buffer_load_dwordx4 a[100:103], v15, s[24:27], s38 offen offset:2048 sc1
    buffer_load_dwordx4 a[104:107], v14, s[24:27], s38 offen offset:2048 sc1
    s_waitcnt vmcnt(9)
    v_mfma_f32_32x32x16_bf16 v[16:31], a[68:71], a[108:111], v[16:31]
    v_mfma_f32_32x32x16_bf16 v[32:47], a[68:71], a[112:115], v[32:47]
    s_waitcnt vmcnt(8)
    v_mfma_f32_32x32x16_bf16 v[48:63], a[72:75], a[108:111], v[48:63]
    v_mfma_f32_32x32x16_bf16 v[64:79], a[72:75], a[112:115], v[64:79]
    buffer_load_dwordx4 v[80:83], v15, s[24:27], s38 offen offset:3072 sc1
    buffer_load_dwordx4 v[84:87], v14, s[24:27], s38 offen offset:3072 sc1
    ds_read_b64_tr_b16 a[108:109], v4 offset:49152
    ds_read_b64_tr_b16 a[110:111], v4 offset:50176
    ds_read_b64_tr_b16 a[112:113], v2 offset:49152
    ds_read_b64_tr_b16 a[114:115], v2 offset:50176
    s_waitcnt vmcnt(9)
    v_mfma_f32_32x32x16_bf16 v[16:31], a[76:79], a[116:119], v[16:31]
    v_mfma_f32_32x32x16_bf16 v[32:47], a[76:79], a[120:123], v[32:47]
    s_waitcnt vmcnt(8)
    v_mfma_f32_32x32x16_bf16 v[48:63], a[80:83], a[116:119], v[48:63]
    v_mfma_f32_32x32x16_bf16 v[64:79], a[80:83], a[120:123], v[64:79]
    s_waitcnt lgkmcnt(0)
    s_barrier
    s_waitcnt vmcnt(7)
    v_mfma_f32_32x32x16_bf16 v[16:31], a[84:87], a[0:3], v[16:31]
    v_mfma_f32_32x32x16_bf16 v[32:47], a[84:87], a[4:7], v[32:47]
    s_waitcnt vmcnt(6)
    v_mfma_f32_32x32x16_bf16 v[48:63], a[88:91], a[0:3], v[48:63]
    v_mfma_f32_32x32x16_bf16 v[64:79], a[88:91], a[4:7], v[64:79]
    s_waitcnt vmcnt(5)
    v_mfma_f32_32x32x16_bf16 v[16:31], a[92:95], a[8:11], v[16:31]
    v_mfma_f32_32x32x16_bf16 v[32:47], a[92:95], a[12:15], v[32:47]
    s_waitcnt vmcnt(4)
    v_mfma_f32_32x32x16_bf16 v[48:63], a[96:99], a[8:11], v[48:63]
    v_mfma_f32_32x32x16_bf16 v[64:79], a[96:99], a[12:15], v[64:79]
    s_waitcnt vmcnt(3)
    v_mfma_f32_32x32x16_bf16 v[16:31], a[100:103], a[16:19], v[16:31]
    v_mfma_f32_32x32x16_bf16 v[32:47], a[100:103], a[20:23], v[32:47]
    s_waitcnt vmcnt(2)
    v_mfma_f32_32x32x16_bf16 v[48:63], a[104:107], a[16:19], v[48:63]
    v_mfma_f32_32x32x16_bf16 v[64:79], a[104:107], a[20:23], v[64:79]
    s_waitcnt vmcnt(1)
    v_mfma_f32_32x32x16_bf16 v[16:31], v[80:83], a[108:111], v[16:31]
    v_mfma_f32_32x32x16_bf16 v[32:47], v[80:83], a[112:115], v[32:47]
    s_waitcnt vmcnt(0)
    v_mfma_f32_32x32x16_bf16 v[48:63], v[84:87], a[108:111], v[48:63]
    v_mfma_f32_32x32x16_bf16 v[64:79], v[84:87], a[112:115], v[64:79]
    v_xor_b32 v2, 16, v6
    s_mov_b32 s64, 0xf0f0f0f0
    s_mov_b32 s65, 0xf0f0f0f0
    s_add_u32 s54, s59, 0x8000
    v_add_u32 v6, 0x10000, v6
    v_add_u32 v2, 0x10000, v2
    s_lshl_b32 s3, s42, 11
    v_add_u32 v12, s3, v15
    v_add_u32 v12, 131072, v12
    s_lshl_b32 s3, s42, 14
    s_add_u32 m0, s3, 16256
    s_nop 0
    ds_write_addtid_b32 v16 offset:49280
    ds_write_addtid_b32 v17 offset:49536
    ds_write_addtid_b32 v18 offset:49792
    ds_write_addtid_b32 v19 offset:50048
    ds_write_addtid_b32 v20 offset:50304
    ds_write_addtid_b32 v21 offset:50560
    ds_write_addtid_b32 v22 offset:50816
    ds_write_addtid_b32 v23 offset:51072
    ds_write_addtid_b32 v24 offset:51328
    ds_write_addtid_b32 v25 offset:51584
    ds_write_addtid_b32 v26 offset:51840
    ds_write_addtid_b32 v27 offset:52096
    ds_write_addtid_b32 v28 offset:52352
    ds_write_addtid_b32 v29 offset:52608
    ds_write_addtid_b32 v30 offset:52864
    ds_write_addtid_b32 v31 offset:53120
    ds_write_addtid_b32 v32 offset:53376
    ds_write_addtid_b32 v33 offset:53632
    ds_write_addtid_b32 v34 offset:53888
    ds_write_addtid_b32 v35 offset:54144
    ds_write_addtid_b32 v36 offset:54400
    ds_write_addtid_b32 v37 offset:54656
    ds_write_addtid_b32 v38 offset:54912
    ds_write_addtid_b32 v39 offset:55168
    ds_write_addtid_b32 v40 offset:55424
    ds_write_addtid_b32 v41 offset:55680
    ds_write_addtid_b32 v42 offset:55936
    ds_write_addtid_b32 v43 offset:56192
    ds_write_addtid_b32 v44 offset:56448
    ds_write_addtid_b32 v45 offset:56704
    ds_write_addtid_b32 v46 offset:56960
    ds_write_addtid_b32 v47 offset:57216
    ds_write_addtid_b32 v48 offset:57472
    ds_write_addtid_b32 v49 offset:57728
    ds_write_addtid_b32 v50 offset:57984
    ds_write_addtid_b32 v51 offset:58240
    ds_write_addtid_b32 v52 offset:58496
    ds_write_addtid_b32 v53 offset:58752
    ds_write_addtid_b32 v54 offset:59008
    ds_write_addtid_b32 v55 offset:59264
    ds_write_addtid_b32 v56 offset:59520
    ds_write_addtid_b32 v57 offset:59776
    ds_write_addtid_b32 v58 offset:60032
    ds_write_addtid_b32 v59 offset:60288
    ds_write_addtid_b32 v60 offset:60544
    ds_write_addtid_b32 v61 offset:60800
    ds_write_addtid_b32 v62 offset:61056
    ds_write_addtid_b32 v63 offset:61312
    ds_write_addtid_b32 v64 offset:61568
    ds_write_addtid_b32 v65 offset:61824
    ds_write_addtid_b32 v66 offset:62080
    ds_write_addtid_b32 v67 offset:62336
    ds_write_addtid_b32 v68 offset:62592
    ds_write_addtid_b32 v69 offset:62848
    ds_write_addtid_b32 v70 offset:63104
    ds_write_addtid_b32 v71 offset:63360
    ds_write_addtid_b32 v72 offset:63616
    ds_write_addtid_b32 v73 offset:63872
    ds_write_addtid_b32 v74 offset:64128
    ds_write_addtid_b32 v75 offset:64384
    ds_write_addtid_b32 v76 offset:64640
    ds_write_addtid_b32 v77 offset:64896
    ds_write_addtid_b32 v78 offset:65152
    ds_write_addtid_b32 v79 offset:65408
    s_waitcnt lgkmcnt(0)
    s_barrier
    ds_read_b128 v[104:107], v12 offset:0
    ds_read_b128 v[108:111], v12 offset:1024
    ds_read_b128 v[48:51], v6 offset:8192
    ds_read_b128 v[52:55], v2 offset:8192
    ds_read_b128 v[56:59], v6 offset:24576
    ds_read_b128 v[60:63], v2 offset:24576
    ds_read_b128 v[64:67], v6 offset:40960
    ds_read_b128 v[68:71], v2 offset:40960
    ds_read_b128 v[72:75], v6 offset:57344
    ds_read_b128 v[76:79], v2 offset:57344
    s_waitcnt lgkmcnt(4)
    v_pk_add_f32 v[48:49], v[48:49], v[56:57]
    v_pk_add_f32 v[50:51], v[50:51], v[58:59]
    v_pk_add_f32 v[52:53], v[52:53], v[60:61]
    v_pk_add_f32 v[54:55], v[54:55], v[62:63]
    v_pk_add_f32 v[48:49], v[48:49], v[104:105]
    v_pk_add_f32 v[50:51], v[50:51], v[106:107]
    v_pk_add_f32 v[52:53], v[52:53], v[108:109]
    v_pk_add_f32 v[54:55], v[54:55], v[110:111]
    s_waitcnt lgkmcnt(0)
    v_pk_add_f32 v[64:65], v[64:65], v[72:73]
    v_pk_add_f32 v[66:67], v[66:67], v[74:75]
    v_pk_add_f32 v[68:69], v[68:69], v[76:77]
    v_pk_add_f32 v[70:71], v[70:71], v[78:79]
    v_pk_add_f32 v[104:105], v[48:49], v[64:65]
    v_pk_add_f32 v[106:107], v[50:51], v[66:67]
    v_pk_add_f32 v[108:109], v[52:53], v[68:69]
    v_pk_add_f32 v[110:111], v[54:55], v[70:71]
    v_cvt_pk_bf16_f32 v48, v104, v105
    v_cvt_pk_bf16_f32 v49, v106, v107
    v_cvt_pk_bf16_f32 v50, v108, v109
    v_cvt_pk_bf16_f32 v51, v110, v111
    v_cndmask_b32_e64 v52, v48, v50, s[64:65]
    v_cndmask_b32_e64 v53, v49, v51, s[64:65]
    v_cndmask_b32_e64 v54, v50, v48, s[64:65]
    v_cndmask_b32_e64 v55, v51, v49, s[64:65]
    buffer_store_dwordx4 v[52:55], v7, s[28:31], s54 offen
    s_endpgm
L_slow_2005:
    s_nop 7
    s_waitcnt lgkmcnt(0)
    ds_read_b128 a[0:3], v12 offset:16384
    ds_read_b128 a[4:7], v12 offset:0
    ds_read_b128 a[8:11], v12 offset:14336
    s_waitcnt lgkmcnt(2)
    v_mfma_f32_32x32x16_bf16 v[16:31], a[0:3], v[120:123], 0
    ds_read_b128 a[0:3], v12 offset:12288
    s_waitcnt lgkmcnt(2)
    v_mfma_f32_32x32x16_bf16 v[32:47], a[4:7], v[120:123], 0
    ds_read_b128 a[4:7], v12 offset:10240
    s_waitcnt lgkmcnt(2)
    v_mfma_f32_32x32x16_bf16 v[48:63], a[8:11], v[120:123], 0
    ds_read_b128 a[8:11], v12 offset:8192
    s_nop 7
    v_cndmask_b32_e64 v16, v16, v32, s[64:65]
    v_cndmask_b32_e64 v17, v17, v33, s[66:67]
    v_cndmask_b32_e64 v18, v18, v34, s[68:69]
    v_cndmask_b32_e64 v19, v19, v35, s[70:71]
    v_cndmask_b32_e64 v20, v20, v36, s[72:73]
    v_cndmask_b32_e64 v21, v21, v37, s[74:75]
    v_cndmask_b32_e64 v22, v22, v38, s[76:77]
    v_cndmask_b32_e64 v23, v23, v39, s[78:79]
    v_cndmask_b32_e64 v24, v24, v40, s[80:81]
    v_cndmask_b32_e64 v25, v25, v41, s[82:83]
    v_cndmask_b32_e64 v26, v26, v42, s[84:85]
    v_cndmask_b32_e64 v27, v27, v43, s[86:87]
    v_cndmask_b32_e64 v28, v28, v44, s[88:89]
    v_cndmask_b32_e64 v29, v29, v45, s[90:91]
    v_cndmask_b32_e64 v30, v30, v46, s[92:93]
    v_cndmask_b32_e64 v31, v31, v47, s[94:95]
    s_waitcnt lgkmcnt(2)
    v_mfma_f32_32x32x16_bf16 v[32:47], a[0:3], v[120:123], 0
    ds_read_b128 a[0:3], v12 offset:6144
    v_max_f32 v80, v16, v17
    v_max_f32 v81, v18, v19
    v_max3_f32 v80, v20, v21, v80
    v_max3_f32 v81, v22, v23, v81
    v_max3_f32 v80, v24, v25, v80
    v_max3_f32 v81, v26, v27, v81
    v_max3_f32 v80, v28, v29, v80
    v_max3_f32 v81, v30, v31, v81
    s_waitcnt lgkmcnt(2)
    v_mfma_f32_32x32x16_bf16 v[16:31], a[4:7], v[120:123], 0
    ds_read_b128 a[4:7], v12 offset:4096
    v_max3_f32 v80, v48, v49, v80
    v_max3_f32 v81, v50, v51, v81
    v_max3_f32 v80, v52, v53, v80
    v_max3_f32 v81, v54, v55, v81
    v_max3_f32 v80, v56, v57, v80
    v_max3_f32 v81, v58, v59, v81
    v_max3_f32 v80, v60, v61, v80
    v_max3_f32 v81, v62, v63, v81
    s_waitcnt lgkmcnt(2)
    v_mfma_f32_32x32x16_bf16 v[48:63], a[8:11], v[120:123], 0
    ds_read_b128 a[8:11], v12 offset:2048
    v_max3_f32 v80, v32, v33, v80
    v_max3_f32 v81, v34, v35, v81
    v_max3_f32 v80, v36, v37, v80
    v_max3_f32 v81, v38, v39, v81
    v_max3_f32 v80, v40, v41, v80
    v_max3_f32 v81, v42, v43, v81
    v_max3_f32 v80, v44, v45, v80
    v_max3_f32 v81, v46, v47, v81
    s_waitcnt lgkmcnt(2)
    v_mfma_f32_32x32x16_bf16 v[32:47], a[0:3], v[120:123], 0
    ds_read_b128 a[0:3], v12 offset:16384
    v_max3_f32 v80, v16, v17, v80
    v_max3_f32 v81, v18, v19, v81
    v_max3_f32 v80, v20, v21, v80
    v_max3_f32 v81, v22, v23, v81
    v_max3_f32 v80, v24, v25, v80
    v_max3_f32 v81, v26, v27, v81
    v_max3_f32 v80, v28, v29, v80
    v_max3_f32 v81, v30, v31, v81
    s_waitcnt lgkmcnt(2)
    v_mfma_f32_32x32x16_bf16 v[16:31], a[4:7], v[120:123], 0
    ds_read_b128 a[4:7], v12 offset:0
    v_max3_f32 v80, v48, v49, v80
    v_max3_f32 v81, v50, v51, v81
    v_max3_f32 v80, v52, v53, v80
    v_max3_f32 v81, v54, v55, v81
    v_max3_f32 v80, v56, v57, v80
    v_max3_f32 v81, v58, v59, v81
    v_max3_f32 v80, v60, v61, v80
    v_max3_f32 v81, v62, v63, v81
    s_waitcnt lgkmcnt(2)
    v_mfma_f32_32x32x16_bf16 v[48:63], a[8:11], v[120:123], 0
    ds_read_b128 a[8:11], v12 offset:14336
    v_max3_f32 v80, v32, v33, v80
    v_max3_f32 v81, v34, v35, v81
    v_max3_f32 v80, v36, v37, v80
    v_max3_f32 v81, v38, v39, v81
    v_max3_f32 v80, v40, v41, v80
    v_max3_f32 v81, v42, v43, v81
    v_max3_f32 v80, v44, v45, v80
    v_max3_f32 v81, v46, v47, v81
    v_max3_f32 v80, v16, v17, v80
    v_max3_f32 v81, v18, v19, v81
    v_max3_f32 v80, v20, v21, v80
    v_max3_f32 v81, v22, v23, v81
    v_max3_f32 v80, v24, v25, v80
    v_max3_f32 v81, v26, v27, v81
    v_max3_f32 v80, v28, v29, v80
    v_max3_f32 v81, v30, v31, v81
    v_max3_f32 v80, v48, v49, v80
    v_max3_f32 v81, v50, v51, v81
    v_max3_f32 v80, v52, v53, v80
    v_max3_f32 v81, v54, v55, v81
    v_max3_f32 v80, v56, v57, v80
    v_max3_f32 v81, v58, v59, v81
    v_max3_f32 v80, v60, v61, v80
    v_max3_f32 v81, v62, v63, v81
    v_max_f32 v80, v80, v81
    v_mov_b32 v81, v80
    s_nop 1
    v_permlane32_swap_b32 v80, v81
    v_max_f32 v80, v80, v81
    v_sub_f32 v48, 0, v80
    v_sub_f32 v49, 0, v80
    v_mov_b64 v[50:51], v[48:49]
    v_mov_b64 v[52:53], v[48:49]
    v_mov_b64 v[54:55], v[48:49]
    v_mov_b64 v[56:57], v[48:49]
    v_mov_b64 v[58:59], v[48:49]
    v_mov_b64 v[60:61], v[48:49]
    v_mov_b64 v[62:63], v[48:49]
    s_waitcnt lgkmcnt(2)
    s_nop 0
    v_mfma_f32_32x32x16_bf16 v[16:31], a[0:3], v[120:123], v[48:63]
    ds_read_b128 a[0:3], v12 offset:12288
    s_waitcnt lgkmcnt(2)
    v_mfma_f32_32x32x16_bf16 v[32:47], a[4:7], v[120:123], v[48:63]
    ds_read_b128 a[4:7], v12 offset:10240
    ds_read_b128 a[12:15], v5 offset:16640
    ds_read_b128 a[16:19], v5 offset:17680
    ds_read_b128 a[20:23], v5 offset:0
    ds_read_b128 a[24:27], v5 offset:1040
    s_nop 6
    v_cndmask_b32_e64 v16, v16, v32, s[64:65]
    v_cndmask_b32_e64 v17, v17, v33, s[66:67]
    v_cndmask_b32_e64 v18, v18, v34, s[68:69]
    v_cndmask_b32_e64 v19, v19, v35, s[70:71]
    v_cndmask_b32_e64 v20, v20, v36, s[72:73]
    v_cndmask_b32_e64 v21, v21, v37, s[74:75]
    v_cndmask_b32_e64 v22, v22, v38, s[76:77]
    v_cndmask_b32_e64 v23, v23, v39, s[78:79]
    v_cndmask_b32_e64 v24, v24, v40, s[80:81]
    v_cndmask_b32_e64 v25, v25, v41, s[82:83]
    v_cndmask_b32_e64 v26, v26, v42, s[84:85]
    v_cndmask_b32_e64 v27, v27, v43, s[86:87]
    v_cndmask_b32_e64 v28, v28, v44, s[88:89]
    v_cndmask_b32_e64 v29, v29, v45, s[90:91]
    v_cndmask_b32_e64 v30, v30, v46, s[92:93]
    v_cndmask_b32_e64 v31, v31, v47, s[94:95]
    s_waitcnt lgkmcnt(6)
    v_mfma_f32_32x32x16_bf16 v[32:47], a[8:11], v[120:123], v[48:63]
    ds_read_b128 a[8:11], v12 offset:8192
    v_exp_f32 v16, v16
    v_exp_f32 v17, v17
    v_exp_f32 v18, v18
    v_exp_f32 v19, v19
    v_exp_f32 v20, v20
    v_exp_f32 v21, v21
    v_exp_f32 v22, v22
    v_exp_f32 v23, v23
    v_exp_f32 v24, v24
    v_exp_f32 v25, v25
    v_exp_f32 v26, v26
    v_exp_f32 v27, v27
    v_exp_f32 v28, v28
    v_exp_f32 v29, v29
    v_exp_f32 v30, v30
    v_exp_f32 v31, v31
    v_cvt_pk_bf16_f32 v96, v16, v17
    v_cvt_pk_bf16_f32 v97, v18, v19
    v_cvt_pk_bf16_f32 v98, v20, v21
    v_cvt_pk_bf16_f32 v99, v22, v23
    v_cvt_pk_bf16_f32 v100, v24, v25
    v_cvt_pk_bf16_f32 v101, v26, v27
    v_cvt_pk_bf16_f32 v102, v28, v29
    v_cvt_pk_bf16_f32 v103, v30, v31
    s_waitcnt lgkmcnt(6)
    v_mfma_f32_32x32x16_bf16 v[16:31], a[0:3], v[120:123], v[48:63]
    ds_read_b128 a[0:3], v12 offset:6144
    v_and_b32 v104, v96, v88
    v_and_b32 v105, v97, v89
    v_and_b32 v106, v98, v90
    v_and_b32 v107, v99, v91
    v_and_b32 v108, v100, v92
    v_and_b32 v109, v101, v93
    v_and_b32 v110, v102, v94
    v_and_b32 v111, v103, v95
    v_xor_b32 v96, v96, v104
    v_xor_b32 v97, v97, v105
    v_xor_b32 v98, v98, v106
    v_xor_b32 v99, v99, v107
    v_xor_b32 v100, v100, v108
    v_xor_b32 v101, v101, v109
    v_xor_b32 v102, v102, v110
    v_xor_b32 v103, v103, v111
    s_waitcnt lgkmcnt(3)
    v_mfma_f32_32x32x16_bf16 v[64:79], a[20:23], v[104:107], 0
    s_waitcnt lgkmcnt(2)
    v_mfma_f32_32x32x16_bf16 v[64:79], a[24:27], v[108:111], v[64:79]
    v_mfma_f32_32x32x16_bf16 v[64:79], a[12:15], v[96:99], v[64:79]
    v_mfma_f32_32x32x16_bf16 v[64:79], a[16:19], v[100:103], v[64:79]
    ds_read_b128 a[20:23], v5 offset:14560
    ds_read_b128 a[24:27], v5 offset:15600
    ds_read_b128 a[12:15], v5 offset:12480
    ds_read_b128 a[16:19], v5 offset:13520
    v_exp_f32 v32, v32
    v_exp_f32 v33, v33
    v_exp_f32 v34, v34
    v_exp_f32 v35, v35
    v_exp_f32 v36, v36
    v_exp_f32 v37, v37
    v_exp_f32 v38, v38
    v_exp_f32 v39, v39
    v_exp_f32 v40, v40
    v_exp_f32 v41, v41
    v_exp_f32 v42, v42
    v_exp_f32 v43, v43
    v_exp_f32 v44, v44
    v_exp_f32 v45, v45
    v_exp_f32 v46, v46
    v_exp_f32 v47, v47
    v_cvt_pk_bf16_f32 v104, v32, v33
    v_cvt_pk_bf16_f32 v105, v34, v35
    v_cvt_pk_bf16_f32 v106, v36, v37
    v_cvt_pk_bf16_f32 v107, v38, v39
    v_cvt_pk_bf16_f32 v108, v40, v41
    v_cvt_pk_bf16_f32 v109, v42, v43
    v_cvt_pk_bf16_f32 v110, v44, v45
    v_cvt_pk_bf16_f32 v111, v46, v47
    v_mfma_f32_32x32x16_bf16 v[32:47], a[4:7], v[120:123], v[48:63]
    ds_read_b128 a[4:7], v12 offset:4096
    s_waitcnt lgkmcnt(4)
    v_mfma_f32_32x32x16_bf16 v[64:79], a[20:23], v[104:107], v[64:79]
    s_waitcnt lgkmcnt(3)
    v_mfma_f32_32x32x16_bf16 v[64:79], a[24:27], v[108:111], v[64:79]
    ds_read_b128 a[20:23], v5 offset:10400
    ds_read_b128 a[24:27], v5 offset:11440
    v_exp_f32 v16, v16
    v_exp_f32 v17, v17
    v_exp_f32 v18, v18
    v_exp_f32 v19, v19
    v_exp_f32 v20, v20
    v_exp_f32 v21, v21
    v_exp_f32 v22, v22
    v_exp_f32 v23, v23
    v_exp_f32 v24, v24
    v_exp_f32 v25, v25
    v_exp_f32 v26, v26
    v_exp_f32 v27, v27
    v_exp_f32 v28, v28
    v_exp_f32 v29, v29
    v_exp_f32 v30, v30
    v_exp_f32 v31, v31
    v_cvt_pk_bf16_f32 v96, v16, v17
    v_cvt_pk_bf16_f32 v97, v18, v19
    v_cvt_pk_bf16_f32 v98, v20, v21
    v_cvt_pk_bf16_f32 v99, v22, v23
    v_cvt_pk_bf16_f32 v100, v24, v25
    v_cvt_pk_bf16_f32 v101, v26, v27
    v_cvt_pk_bf16_f32 v102, v28, v29
    v_cvt_pk_bf16_f32 v103, v30, v31
    v_mfma_f32_32x32x16_bf16 v[16:31], a[8:11], v[120:123], v[48:63]
    ds_read_b128 a[8:11], v12 offset:2048
    s_waitcnt lgkmcnt(5)
    v_mfma_f32_32x32x16_bf16 v[64:79], a[12:15], v[96:99], v[64:79]
    s_waitcnt lgkmcnt(4)
    v_mfma_f32_32x32x16_bf16 v[64:79], a[16:19], v[100:103], v[64:79]
    ds_read_b128 a[12:15], v5 offset:8320
    ds_read_b128 a[16:19], v5 offset:9360
    v_exp_f32 v32, v32
    v_exp_f32 v33, v33
    v_exp_f32 v34, v34
    v_exp_f32 v35, v35
    v_exp_f32 v36, v36
    v_exp_f32 v37, v37
    v_exp_f32 v38, v38
    v_exp_f32 v39, v39
    v_exp_f32 v40, v40
    v_exp_f32 v41, v41
    v_exp_f32 v42, v42
    v_exp_f32 v43, v43
    v_exp_f32 v44, v44
    v_exp_f32 v45, v45
    v_exp_f32 v46, v46
    v_exp_f32 v47, v47
    v_cvt_pk_bf16_f32 v104, v32, v33
    v_cvt_pk_bf16_f32 v105, v34, v35
    v_cvt_pk_bf16_f32 v106, v36, v37
    v_cvt_pk_bf16_f32 v107, v38, v39
    v_cvt_pk_bf16_f32 v108, v40, v41
    v_cvt_pk_bf16_f32 v109, v42, v43
    v_cvt_pk_bf16_f32 v110, v44, v45
    v_cvt_pk_bf16_f32 v111, v46, v47
    v_mfma_f32_32x32x16_bf16 v[32:47], a[0:3], v[120:123], v[48:63]
    s_waitcnt lgkmcnt(4)
    v_mfma_f32_32x32x16_bf16 v[64:79], a[20:23], v[104:107], v[64:79]
    s_waitcnt lgkmcnt(3)
    v_mfma_f32_32x32x16_bf16 v[64:79], a[24:27], v[108:111], v[64:79]
    ds_read_b128 a[20:23], v5 offset:6240
    ds_read_b128 a[24:27], v5 offset:7280
    v_exp_f32 v16, v16
    v_exp_f32 v17, v17
    v_exp_f32 v18, v18
    v_exp_f32 v19, v19
    v_exp_f32 v20, v20
    v_exp_f32 v21, v21
    v_exp_f32 v22, v22
    v_exp_f32 v23, v23
    v_exp_f32 v24, v24
    v_exp_f32 v25, v25
    v_exp_f32 v26, v26
    v_exp_f32 v27, v27
    v_exp_f32 v28, v28
    v_exp_f32 v29, v29
    v_exp_f32 v30, v30
    v_exp_f32 v31, v31
    v_cvt_pk_bf16_f32 v96, v16, v17
    v_cvt_pk_bf16_f32 v97, v18, v19
    v_cvt_pk_bf16_f32 v98, v20, v21
    v_cvt_pk_bf16_f32 v99, v22, v23
    v_cvt_pk_bf16_f32 v100, v24, v25
    v_cvt_pk_bf16_f32 v101, v26, v27
    v_cvt_pk_bf16_f32 v102, v28, v29
    v_cvt_pk_bf16_f32 v103, v30, v31
    v_mfma_f32_32x32x16_bf16 v[16:31], a[4:7], v[120:123], v[48:63]
    s_waitcnt lgkmcnt(3)
    v_mfma_f32_32x32x16_bf16 v[64:79], a[12:15], v[96:99], v[64:79]
    s_waitcnt lgkmcnt(2)
    v_mfma_f32_32x32x16_bf16 v[64:79], a[16:19], v[100:103], v[64:79]
    ds_read_b128 a[12:15], v5 offset:4160
    ds_read_b128 a[16:19], v5 offset:5200
    v_exp_f32 v32, v32
    v_exp_f32 v33, v33
    v_exp_f32 v34, v34
    v_exp_f32 v35, v35
    v_exp_f32 v36, v36
    v_exp_f32 v37, v37
    v_exp_f32 v38, v38
    v_exp_f32 v39, v39
    v_exp_f32 v40, v40
    v_exp_f32 v41, v41
    v_exp_f32 v42, v42
    v_exp_f32 v43, v43
    v_exp_f32 v44, v44
    v_exp_f32 v45, v45
    v_exp_f32 v46, v46
    v_exp_f32 v47, v47
    v_cvt_pk_bf16_f32 v104, v32, v33
    v_cvt_pk_bf16_f32 v105, v34, v35
    v_cvt_pk_bf16_f32 v106, v36, v37
    v_cvt_pk_bf16_f32 v107, v38, v39
    v_cvt_pk_bf16_f32 v108, v40, v41
    v_cvt_pk_bf16_f32 v109, v42, v43
    v_cvt_pk_bf16_f32 v110, v44, v45
    v_cvt_pk_bf16_f32 v111, v46, v47
    v_mfma_f32_32x32x16_bf16 v[32:47], a[8:11], v[120:123], v[48:63]
    s_waitcnt lgkmcnt(3)
    v_mfma_f32_32x32x16_bf16 v[64:79], a[20:23], v[104:107], v[64:79]
    s_waitcnt lgkmcnt(2)
    v_mfma_f32_32x32x16_bf16 v[64:79], a[24:27], v[108:111], v[64:79]
    ds_read_b128 a[20:23], v5 offset:2080
    ds_read_b128 a[24:27], v5 offset:3120
    v_exp_f32 v16, v16
    v_exp_f32 v17, v17
    v_exp_f32 v18, v18
    v_exp_f32 v19, v19
    v_exp_f32 v20, v20
    v_exp_f32 v21, v21
    v_exp_f32 v22, v22
    v_exp_f32 v23, v23
    v_exp_f32 v24, v24
    v_exp_f32 v25, v25
    v_exp_f32 v26, v26
    v_exp_f32 v27, v27
    v_exp_f32 v28, v28
    v_exp_f32 v29, v29
    v_exp_f32 v30, v30
    v_exp_f32 v31, v31
    v_cvt_pk_bf16_f32 v96, v16, v17
    v_cvt_pk_bf16_f32 v97, v18, v19
    v_cvt_pk_bf16_f32 v98, v20, v21
    v_cvt_pk_bf16_f32 v99, v22, v23
    v_cvt_pk_bf16_f32 v100, v24, v25
    v_cvt_pk_bf16_f32 v101, v26, v27
    v_cvt_pk_bf16_f32 v102, v28, v29
    v_cvt_pk_bf16_f32 v103, v30, v31
    s_waitcnt lgkmcnt(3)
    v_mfma_f32_32x32x16_bf16 v[64:79], a[12:15], v[96:99], v[64:79]
    s_waitcnt lgkmcnt(2)
    v_mfma_f32_32x32x16_bf16 v[64:79], a[16:19], v[100:103], v[64:79]
    v_exp_f32 v32, v32
    v_exp_f32 v33, v33
    v_exp_f32 v34, v34
    v_exp_f32 v35, v35
    v_exp_f32 v36, v36
    v_exp_f32 v37, v37
    v_exp_f32 v38, v38
    v_exp_f32 v39, v39
    v_exp_f32 v40, v40
    v_exp_f32 v41, v41
    v_exp_f32 v42, v42
    v_exp_f32 v43, v43
    v_exp_f32 v44, v44
    v_exp_f32 v45, v45
    v_exp_f32 v46, v46
    v_exp_f32 v47, v47
    v_cvt_pk_bf16_f32 v104, v32, v33
    v_cvt_pk_bf16_f32 v105, v34, v35
    v_cvt_pk_bf16_f32 v106, v36, v37
    v_cvt_pk_bf16_f32 v107, v38, v39
    v_cvt_pk_bf16_f32 v108, v40, v41
    v_cvt_pk_bf16_f32 v109, v42, v43
    v_cvt_pk_bf16_f32 v110, v44, v45
    v_cvt_pk_bf16_f32 v111, v46, v47
    s_waitcnt lgkmcnt(1)
    v_mfma_f32_32x32x16_bf16 v[64:79], a[20:23], v[104:107], v[64:79]
    s_waitcnt lgkmcnt(0)
    v_mfma_f32_32x32x16_bf16 v[64:79], a[24:27], v[108:111], v[64:79]
    s_nop 15
    s_branch L_back_2006
L_exit:
    s_endpgm
.section .rodata,"a"
.p2align 6
.amdhsa_kernel gated_mix__sliding_block__glu_gated_glu__prompt_kernel
  .amdhsa_next_free_vgpr 256
  .amdhsa_next_free_sgpr 102
  .amdhsa_accum_offset 128
  .amdhsa_group_segment_fixed_size 0
  .amdhsa_kernarg_size 88
  .amdhsa_user_sgpr_count 2
  .amdhsa_user_sgpr_kernarg_segment_ptr 1
  .amdhsa_system_sgpr_workgroup_id_x 1
.end_amdhsa_kernel
```
